```python
import torch

def _softmax(x, axis=-1):
    return torch.softmax(x, dim=axis)

def _gelu(x):
    return torch.nn.functional.gelu(x, approximate='tanh')

def _silu(x):
    return torch.nn.functional.silu(x)

def _sigmoid(x):
    return torch.sigmoid(x)

def _layernorm(x, axis=-1, eps=1e-05):
    m = x.mean(dim=axis, keepdim=True)
    v = x.var(dim=axis, keepdim=True, unbiased=False)
    return (x - m) / torch.sqrt(v + eps)

def _scatter_add(tgt, idx, src, axis=0):
    return tgt.clone().index_add_(axis, idx, src)

def _segment_sum(src, seg, n):
    out = torch.zeros((n,) + src.shape[1:], dtype=src.dtype)
    return out.index_add_(0, seg, src)

def _pad(x, pw):
    flat = tuple((v for pair in reversed(pw) for v in pair))
    return torch.nn.functional.pad(x, flat)
kernel_name = 'adaLN_cond__compressed_kv_cla__dense_activation_relu__decode'

def setup_inputs():

    _w = lambda a: (lambda t: t.to(torch.bfloat16) if t.is_floating_point() else t)(torch.as_tensor(a))

    def _A_setup():
        B, H, Sq, Sk, D, M = (1, 32, 1, 32768, 128, 640)
        Dc = 4 * D
        return {'x': _w((lambda *s: torch.randn(*s, dtype=torch.bfloat16) * 0.05)(B, Sq, M)), 'c_kv': _w((lambda *s: torch.randn(*s, dtype=torch.bfloat16) * 1.6)(B, Sk, Dc)), 'w_q': _w((lambda *s: torch.randn(*s, dtype=torch.bfloat16) * 1.6)(M, H, D) * M ** (-0.5)), 'w_uk': _w((lambda *s: torch.randn(*s, dtype=torch.bfloat16) * 1.6)(Dc, H, D) * Dc ** (-0.5)), 'w_uv': _w((lambda *s: torch.randn(*s, dtype=torch.bfloat16) * 1.6)(Dc, H, D) * Dc ** (-0.5)), 'w_o': _w((lambda *s: torch.randn(*s, dtype=torch.bfloat16) * 1.6)(H, D, M) * (H * D) ** (-0.5))}
    _A_in = _A_setup()

    def _B_setup():
        B, S, D, Dff = (1, 1, 640, 1728)
        return {'x': _w((lambda *s: torch.randn(*s, dtype=torch.bfloat16) * 0.05)(B, S, D)), 'w1': _w((lambda *s: torch.randn(*s, dtype=torch.bfloat16) * 0.05)(D, Dff)), 'w2': _w((lambda *s: torch.randn(*s, dtype=torch.bfloat16) * 0.05)(Dff, D))}
    _B_in = _B_setup()
    return {'A_x': _A_in['x'], 'A_c_kv': _A_in['c_kv'], 'A_w_q': _A_in['w_q'], 'A_w_uk': _A_in['w_uk'], 'A_w_uv': _A_in['w_uv'], 'A_w_o': _A_in['w_o'], 'B_x': _B_in['x'], 'B_w1': _B_in['w1'], 'B_w2': _B_in['w2'], 'c': _w((lambda *s: torch.randn(*s, dtype=torch.bfloat16) * 0.2)(1, 640) * 8.0), 'w_mod': _w((lambda *s: torch.randn(*s, dtype=torch.bfloat16) * 0.2)(640, 6 * 640) * 640 ** (-0.5) * 8.0)}

def reference(A_x, A_c_kv, A_w_q, A_w_uk, A_w_uv, A_w_o, B_x, B_w1, B_w2, c, w_mod):

    def _A_ref(x, c_kv, w_q, w_uk, w_uv, w_o):
        B, Sq, M = (x.shape[0], x.shape[1], x.shape[2])
        Sk = c_kv.shape[1]
        H, D = (w_q.shape[1], w_q.shape[2])
        q = torch.einsum('bqm,mhd->bhqd', x, w_q)
        k = torch.einsum('bkc,chd->bhkd', c_kv, w_uk)
        v = torch.einsum('bkc,chd->bhkd', c_kv, w_uv)
        scores = torch.einsum('bhqd,bhkd->bhqk', q, k) * D ** (-0.5)
        off = Sk - Sq
        qi = torch.arange(Sq)[:, None]
        kj = torch.arange(Sk)[None, :]
        cmask = kj <= qi + off
        scores = torch.where(cmask[None, None], scores, -1000000000.0)
        p = _softmax(scores, axis=-1)
        ctx = torch.einsum('bhqk,bhkd->bhqd', p, v)
        return torch.einsum('bhqd,hdm->bqm', ctx, w_o)

    def _B_ref(x, w1, w2):
        h = torch.einsum('bsd,df->bsf', x, w1)
        zero = torch.zeros_like(h)
        h = torch.maximum(h, zero)
        return torch.einsum('bsf,fd->bsd', h, w2)
    x = A_x
    mod = (_silu(c) @ w_mod).reshape(c.shape[0], 6, 1, -1)
    sa, ca, ga, sb, cb, gb = (mod[:, 0].clone(), mod[:, 1].clone(), mod[:, 2].clone(), mod[:, 3].clone(), mod[:, 4].clone(), mod[:, 5].clone())
    h = _layernorm(x, axis=-1) * (1 + ca) + sa
    x = x + ga * _A_ref(h, A_c_kv, A_w_q, A_w_uk, A_w_uv, A_w_o)
    h = _layernorm(x, axis=-1) * (1 + cb) + sb
    x = x + gb * _B_ref(h, B_w1, B_w2)
    return x
```

```asm
; @launch grid=(256,1,1) block=(256,1,1) lds=163840
.amdgcn_target "amdgcn-amd-amdhsa--gfx950"
.text
.globl adaLN_cond__compressed_kv_cla__dense_activation_relu__decode_kernel
.p2align 8
.type adaLN_cond__compressed_kv_cla__dense_activation_relu__decode_kernel,@function
adaLN_cond__compressed_kv_cla__dense_activation_relu__decode_kernel:
    s_cmp_ge_u32 s2, 256
    s_cbranch_scc1 L_END
    s_load_dwordx16 s[16:31], s[0:1], 0
    s_load_dwordx8 s[32:39], s[0:1], 64
    s_load_dwordx2 s[40:41], s[0:1], 104
    s_sub_u32 s3, s2, 40
    s_add_u32 s5, s2, 88
    s_cmp_lt_u32 s2, 40
    s_cselect_b32 s3, s5, s3
    s_cmp_ge_u32 s2, 128
    s_cselect_b32 s3, s2, s3
    v_and_b32 v1, 63, v0
    v_and_b32 v2, 15, v0
    v_bfe_u32 v3, v0, 4, 2
    v_lshrrev_b32 v20, 6, v0
    s_mov_b32 s56, 0x01000100
    s_mov_b32 s57, 0x03020302
    s_mov_b32 s59, 0x10000
    v_readfirstlane_b32 s4, v20
    v_lshrrev_b32 v24, 3, v2
    v_lshl_add_u32 v24, v24, 2, v3
    v_mul_u32_u24 v24, 10, v24
    s_mul_i32 s8, s4, 80
    v_add_u32 v24, s8, v24
    s_waitcnt lgkmcnt(0)
    s_load_dword s42, s[40:41], 0
    s_mov_b32 s44, s40
    s_mov_b32 s45, s41
    s_mov_b32 s46, 9961472
    s_mov_b32 s47, 0x20000
    s_cmp_lt_u32 s3, 64
    s_cbranch_scc1 L_S1
    s_cmp_lt_u32 s3, 88
    s_cbranch_scc1 L_NOS0
    s_cmp_ge_u32 s3, 128
    s_cbranch_scc1 L_S2ONLY
    s_sub_u32 s5, s3, 88
    s_lshr_b32 s6, s5, 1
    s_and_b32 s7, s5, 1
    s_mov_b32 s48, s36
    s_mov_b32 s49, s37
    s_mov_b32 s50, 4915200
    s_mov_b32 s51, 0x20000
    s_mov_b32 s52, s34
    s_mov_b32 s53, s35
    s_mov_b32 s54, 1280
    s_mov_b32 s55, 0x20000
    s_mul_i32 s9, s7, 320
    v_add_u32 v20, s9, v24
    s_movk_i32 s10, 7680
    v_mul_lo_u32 v20, v20, s10
    v_and_b32 v21, 7, v2
    v_lshlrev_b32 v21, 4, v21
    s_lshl_b32 s11, s6, 7
    v_add3_u32 v20, v20, v21, s11
    v_lshlrev_b32 v21, 2, v0
    s_mul_i32 s12, s7, 640
    buffer_load_dword v25, v21, s[52:55], s12 offen
    s_mov_b32 s12, 0
    buffer_load_dwordx4 v[32:35], v20, s[48:51], s12 offen nt
    s_mov_b32 s12, 7680
    buffer_load_dwordx4 v[36:39], v20, s[48:51], s12 offen nt
    s_mov_b32 s12, 15360
    buffer_load_dwordx4 v[40:43], v20, s[48:51], s12 offen nt
    s_mov_b32 s12, 23040
    buffer_load_dwordx4 v[44:47], v20, s[48:51], s12 offen nt
    s_mov_b32 s12, 30720
    buffer_load_dwordx4 v[48:51], v20, s[48:51], s12 offen nt
    s_mov_b32 s12, 38400
    buffer_load_dwordx4 v[52:55], v20, s[48:51], s12 offen nt
    s_mov_b32 s12, 46080
    buffer_load_dwordx4 v[56:59], v20, s[48:51], s12 offen nt
    s_mov_b32 s12, 53760
    buffer_load_dwordx4 v[60:63], v20, s[48:51], s12 offen nt
    s_mov_b32 s12, 61440
    buffer_load_dwordx4 v[64:67], v20, s[48:51], s12 offen nt
    s_mov_b32 s12, 69120
    buffer_load_dwordx4 v[68:71], v20, s[48:51], s12 offen nt
    v_and_b32 v20, 1, v0
    v_lshlrev_b32 v20, 4, v20
    v_mov_b32 v21, 0xffff
    v_lshlrev_b32 v21, v20, v21
    v_bfe_u32 v22, v0, 1, 2
    v_cmp_eq_u32 vcc, 0, v22
    s_nop 1
    v_cndmask_b32 v4, 0, v21, vcc
    v_cmp_eq_u32 vcc, 1, v22
    s_nop 1
    v_cndmask_b32 v5, 0, v21, vcc
    v_cmp_eq_u32 vcc, 2, v22
    s_nop 1
    v_cndmask_b32 v6, 0, v21, vcc
    v_cmp_eq_u32 vcc, 3, v22
    s_nop 1
    v_cndmask_b32 v7, 0, v21, vcc
    s_waitcnt lgkmcnt(0)
    s_mul_i32 s8, s42, 0x9e3779b1
    s_add_u32 s97, s8, 0x7f4a7c15
    s_and_b32 s42, s97, 0xbfffbfff
    s_waitcnt vmcnt(10)
    v_lshlrev_b32 v26, 16, v25
    v_and_b32 v27, 0xffff0000, v25
    v_mul_f32 v28, 0xbfb8aa3b, v26
    v_exp_f32 v28, v28
    s_nop 0
    v_add_f32 v28, 1.0, v28
    v_rcp_f32 v28, v28
    s_nop 0
    v_mul_f32 v26, v26, v28
    v_mul_f32 v28, 0xbfb8aa3b, v27
    v_exp_f32 v28, v28
    s_nop 0
    v_add_f32 v28, 1.0, v28
    v_rcp_f32 v28, v28
    s_nop 0
    v_mul_f32 v27, v27, v28
    v_cvt_pk_bf16_f32 v26, v26, v27
    v_perm_b32 v28, v26, v26, s56
    v_perm_b32 v29, v26, v26, s57
    v_lshlrev_b32 v21, 3, v0
    v_add_u32 v21, 131072, v21
    v_cmp_gt_u32 vcc, 160, v0
    s_and_saveexec_b64 s[14:15], vcc
    s_cbranch_execz L_1
    ds_write_b64 v21, v[28:29]
L_1:
    s_mov_b64 exec, s[14:15]
    s_waitcnt lgkmcnt(0)
    s_barrier
    v_lshlrev_b32 v21, 2, v24
    v_add_u32 v21, 131072, v21
    ds_read_b64 v[192:193], v21 offset:0
    ds_read_b64 v[194:195], v21 offset:8
    ds_read_b64 v[196:197], v21 offset:16
    ds_read_b64 v[198:199], v21 offset:24
    ds_read_b64 v[200:201], v21 offset:32
    v_lshrrev_b32 v20, 3, v2
    v_lshrrev_b32 v21, 1, v3
    v_cmp_eq_u32 s[12:13], v20, v21
    s_lshl_b32 s8, s4, 1
    v_add_u32 v20, s8, v20
    v_lshlrev_b32 v20, 8, v20
    v_and_b32 v21, 7, v2
    v_lshlrev_b32 v21, 5, v21
    v_and_b32 v22, 1, v3
    v_lshlrev_b32 v22, 4, v22
    v_add3_u32 v20, v20, v21, v22
    v_add_u32 v20, 135168, v20
    s_waitcnt vmcnt(0) lgkmcnt(0)
    v_and_b32 v8, v192, v4
    v_and_b32 v9, v192, v5
    v_and_b32 v10, v192, v6
    v_and_b32 v11, v192, v7
    v_and_b32 v12, v193, v4
    v_and_b32 v13, v193, v5
    v_and_b32 v14, v193, v6
    v_and_b32 v15, v193, v7
    v_mfma_f32_16x16x32_bf16 v[16:19], v[8:11], v[32:35], 0
    v_and_b32 v8, v194, v4
    v_and_b32 v9, v194, v5
    v_and_b32 v10, v194, v6
    v_and_b32 v11, v194, v7
    v_mfma_f32_16x16x32_bf16 v[16:19], v[12:15], v[36:39], v[16:19]
    v_and_b32 v12, v195, v4
    v_and_b32 v13, v195, v5
    v_and_b32 v14, v195, v6
    v_and_b32 v15, v195, v7
    v_mfma_f32_16x16x32_bf16 v[16:19], v[8:11], v[40:43], v[16:19]
    v_and_b32 v8, v196, v4
    v_and_b32 v9, v196, v5
    v_and_b32 v10, v196, v6
    v_and_b32 v11, v196, v7
    v_mfma_f32_16x16x32_bf16 v[16:19], v[12:15], v[44:47], v[16:19]
    v_and_b32 v12, v197, v4
    v_and_b32 v13, v197, v5
    v_and_b32 v14, v197, v6
    v_and_b32 v15, v197, v7
    v_mfma_f32_16x16x32_bf16 v[16:19], v[8:11], v[48:51], v[16:19]
    v_and_b32 v8, v198, v4
    v_and_b32 v9, v198, v5
    v_and_b32 v10, v198, v6
    v_and_b32 v11, v198, v7
    v_mfma_f32_16x16x32_bf16 v[16:19], v[12:15], v[52:55], v[16:19]
    v_and_b32 v12, v199, v4
    v_and_b32 v13, v199, v5
    v_and_b32 v14, v199, v6
    v_and_b32 v15, v199, v7
    v_mfma_f32_16x16x32_bf16 v[16:19], v[8:11], v[56:59], v[16:19]
    v_and_b32 v8, v200, v4
    v_and_b32 v9, v200, v5
    v_and_b32 v10, v200, v6
    v_and_b32 v11, v200, v7
    v_mfma_f32_16x16x32_bf16 v[16:19], v[12:15], v[60:63], v[16:19]
    v_and_b32 v12, v201, v4
    v_and_b32 v13, v201, v5
    v_and_b32 v14, v201, v6
    v_and_b32 v15, v201, v7
    v_mfma_f32_16x16x32_bf16 v[16:19], v[8:11], v[64:67], v[16:19]
    s_nop 1
    v_mfma_f32_16x16x32_bf16 v[16:19], v[12:15], v[68:71], v[16:19]
    s_nop 7
    s_mov_b64 s[14:15], exec
    s_mov_b64 exec, s[12:13]
    ds_write_b128 v20, v[16:19]
    s_mov_b64 exec, s[14:15]
    s_waitcnt lgkmcnt(0)
    s_barrier
    v_cmp_gt_u32 vcc, 32, v0
    s_and_saveexec_b64 s[14:15], vcc
    s_cbranch_execz L_2
    v_lshlrev_b32 v20, 3, v0
    v_add_u32 v21, 135168, v20
    ds_read_b64 v[192:193], v21 offset:0
    ds_read_b64 v[194:195], v21 offset:256
    ds_read_b64 v[196:197], v21 offset:512
    ds_read_b64 v[198:199], v21 offset:768
    ds_read_b64 v[200:201], v21 offset:1024
    ds_read_b64 v[202:203], v21 offset:1280
    ds_read_b64 v[204:205], v21 offset:1536
    ds_read_b64 v[206:207], v21 offset:1792
    s_lshl_b32 s8, s7, 14
    s_lshl_b32 s9, s6, 8
    s_add_u32 s8, s8, s9
    s_add_u32 s8, s8, 4096
    v_mov_b32 v23, s42
    s_waitcnt lgkmcnt(0)
    v_pk_add_f32 v[192:193], v[192:193], v[200:201]
    v_pk_add_f32 v[194:195], v[194:195], v[202:203]
    v_pk_add_f32 v[196:197], v[196:197], v[204:205]
    v_pk_add_f32 v[198:199], v[198:199], v[206:207]
    v_pk_add_f32 v[192:193], v[192:193], v[196:197]
    v_pk_add_f32 v[194:195], v[194:195], v[198:199]
    v_pk_add_f32 v[192:193], v[192:193], v[194:195]
    v_cvt_pk_bf16_f32 v22, v192, v193
    buffer_store_dwordx2 v[22:23], v20, s[44:47], s8 offen sc1
L_2:
    s_mov_b64 exec, s[14:15]
    s_lshl_b32 s8, s3, 17
    s_add_u32 s92, s18, s8
    s_addc_u32 s93, s19, 0
    s_mov_b32 s94, 131072
    s_mov_b32 s95, 0x20000
    v_lshlrev_b32 v19, 4, v1
    s_lshl_b32 s96, s4, 15
    v_lshlrev_b32 v31, 4, v1
    s_mov_b32 m0, s96
    v_xor_b32 v30, 0, v31
    buffer_load_dwordx4 v30, s[92:95], s96 offen nt lds
    s_add_u32 s96, s96, 1024
    s_mov_b32 m0, s96
    v_xor_b32 v30, 64, v31
    buffer_load_dwordx4 v30, s[92:95], s96 offen nt lds
    s_add_u32 s96, s96, 1024
    s_mov_b32 m0, s96
    v_xor_b32 v30, 128, v31
    buffer_load_dwordx4 v30, s[92:95], s96 offen nt lds
    s_add_u32 s96, s96, 1024
    s_mov_b32 m0, s96
    v_xor_b32 v30, 192, v31
    buffer_load_dwordx4 v30, s[92:95], s96 offen nt lds
    s_add_u32 s96, s96, 1024
    s_mov_b32 m0, s96
    v_xor_b32 v30, 16, v31
    buffer_load_dwordx4 v30, s[92:95], s96 offen nt lds
    s_add_u32 s96, s96, 1024
    s_mov_b32 m0, s96
    v_xor_b32 v30, 80, v31
    buffer_load_dwordx4 v30, s[92:95], s96 offen nt lds
    s_add_u32 s96, s96, 1024
    s_mov_b32 m0, s96
    v_xor_b32 v30, 144, v31
    buffer_load_dwordx4 v30, s[92:95], s96 offen nt lds
    s_add_u32 s96, s96, 1024
    s_mov_b32 m0, s96
    v_xor_b32 v30, 208, v31
    buffer_load_dwordx4 v30, s[92:95], s96 offen nt lds
    s_add_u32 s96, s96, 1024
    s_mov_b32 m0, s96
    v_xor_b32 v30, 32, v31
    buffer_load_dwordx4 v30, s[92:95], s96 offen nt lds
    s_add_u32 s96, s96, 1024
    s_mov_b32 m0, s96
    v_xor_b32 v30, 96, v31
    buffer_load_dwordx4 v30, s[92:95], s96 offen nt lds
    s_add_u32 s96, s96, 1024
    s_mov_b32 m0, s96
    v_xor_b32 v30, 160, v31
    buffer_load_dwordx4 v30, s[92:95], s96 offen nt lds
    s_add_u32 s96, s96, 1024
    s_mov_b32 m0, s96
    v_xor_b32 v30, 224, v31
    buffer_load_dwordx4 v30, s[92:95], s96 offen nt lds
    s_add_u32 s96, s96, 1024
    s_mov_b32 m0, s96
    v_xor_b32 v30, 48, v31
    buffer_load_dwordx4 v30, s[92:95], s96 offen nt lds
    s_add_u32 s96, s96, 1024
    s_mov_b32 m0, s96
    v_xor_b32 v30, 112, v31
    buffer_load_dwordx4 v30, s[92:95], s96 offen nt lds
    s_add_u32 s96, s96, 1024
    s_mov_b32 m0, s96
    v_xor_b32 v30, 176, v31
    buffer_load_dwordx4 v30, s[92:95], s96 offen nt lds
    s_add_u32 s96, s96, 1024
    s_mov_b32 m0, s96
    v_xor_b32 v30, 240, v31
    buffer_load_dwordx4 v30, s[92:95], s96 offen nt lds
    s_add_u32 s96, s96, 1024
    s_mov_b32 m0, s96
    v_xor_b32 v30, 0, v31
    buffer_load_dwordx4 v30, s[92:95], s96 offen nt lds
    s_add_u32 s96, s96, 1024
    s_mov_b32 m0, s96
    v_xor_b32 v30, 64, v31
    buffer_load_dwordx4 v30, s[92:95], s96 offen nt lds
    s_add_u32 s96, s96, 1024
    s_mov_b32 m0, s96
    v_xor_b32 v30, 128, v31
    buffer_load_dwordx4 v30, s[92:95], s96 offen nt lds
    s_add_u32 s96, s96, 1024
    s_mov_b32 m0, s96
    v_xor_b32 v30, 192, v31
    buffer_load_dwordx4 v30, s[92:95], s96 offen nt lds
    s_add_u32 s96, s96, 1024
    s_mov_b32 m0, s96
    v_xor_b32 v30, 16, v31
    buffer_load_dwordx4 v30, s[92:95], s96 offen nt lds
    s_add_u32 s96, s96, 1024
    s_mov_b32 m0, s96
    v_xor_b32 v30, 80, v31
    buffer_load_dwordx4 v30, s[92:95], s96 offen nt lds
    s_add_u32 s96, s96, 1024
    s_mov_b32 m0, s96
    v_xor_b32 v30, 144, v31
    buffer_load_dwordx4 v30, s[92:95], s96 offen nt lds
    s_add_u32 s96, s96, 1024
    s_mov_b32 m0, s96
    v_xor_b32 v30, 208, v31
    buffer_load_dwordx4 v30, s[92:95], s96 offen nt lds
    s_add_u32 s96, s96, 1024
    s_mov_b32 m0, s96
    v_xor_b32 v30, 32, v31
    buffer_load_dwordx4 v30, s[92:95], s96 offen nt lds
    s_add_u32 s96, s96, 1024
    s_mov_b32 m0, s96
    v_xor_b32 v30, 96, v31
    buffer_load_dwordx4 v30, s[92:95], s96 offen nt lds
    s_add_u32 s96, s96, 1024
    s_mov_b32 m0, s96
    v_xor_b32 v30, 160, v31
    buffer_load_dwordx4 v30, s[92:95], s96 offen nt lds
    s_add_u32 s96, s96, 1024
    s_mov_b32 m0, s96
    v_xor_b32 v30, 224, v31
    buffer_load_dwordx4 v30, s[92:95], s96 offen nt lds
    s_add_u32 s96, s96, 1024
    s_mov_b32 m0, s96
    v_xor_b32 v30, 48, v31
    buffer_load_dwordx4 v30, s[92:95], s96 offen nt lds
    s_add_u32 s96, s96, 1024
    s_mov_b32 m0, s96
    v_xor_b32 v30, 112, v31
    buffer_load_dwordx4 v30, s[92:95], s96 offen nt lds
    s_add_u32 s96, s96, 1024
    s_mov_b32 m0, s96
    v_xor_b32 v30, 176, v31
    buffer_load_dwordx4 v30, s[92:95], s96 offen nt lds
    s_add_u32 s96, s96, 1024
    s_mov_b32 m0, s96
    v_xor_b32 v30, 240, v31
    buffer_load_dwordx4 v30, s[92:95], s96 offen nt lds
    s_add_u32 s96, s96, 1024
    s_branch L_DMA_D
L_NOS0:
    v_and_b32 v20, 1, v0
    v_lshlrev_b32 v20, 4, v20
    v_mov_b32 v21, 0xffff
    v_lshlrev_b32 v21, v20, v21
    v_bfe_u32 v22, v0, 1, 2
    v_cmp_eq_u32 vcc, 0, v22
    s_nop 1
    v_cndmask_b32 v4, 0, v21, vcc
    v_cmp_eq_u32 vcc, 1, v22
    s_nop 1
    v_cndmask_b32 v5, 0, v21, vcc
    v_cmp_eq_u32 vcc, 2, v22
    s_nop 1
    v_cndmask_b32 v6, 0, v21, vcc
    v_cmp_eq_u32 vcc, 3, v22
    s_nop 1
    v_cndmask_b32 v7, 0, v21, vcc
    s_waitcnt lgkmcnt(0)
    s_mul_i32 s8, s42, 0x9e3779b1
    s_add_u32 s97, s8, 0x7f4a7c15
    s_and_b32 s42, s97, 0xbfffbfff
    s_lshl_b32 s8, s3, 17
    s_add_u32 s92, s18, s8
    s_addc_u32 s93, s19, 0
    s_mov_b32 s94, 131072
    s_mov_b32 s95, 0x20000
    v_lshlrev_b32 v19, 4, v1
    s_lshl_b32 s96, s4, 15
    v_lshlrev_b32 v31, 4, v1
    s_mov_b32 m0, s96
    v_xor_b32 v30, 0, v31
    buffer_load_dwordx4 v30, s[92:95], s96 offen nt lds
    s_add_u32 s96, s96, 1024
    s_mov_b32 m0, s96
    v_xor_b32 v30, 64, v31
    buffer_load_dwordx4 v30, s[92:95], s96 offen nt lds
    s_add_u32 s96, s96, 1024
    s_mov_b32 m0, s96
    v_xor_b32 v30, 128, v31
    buffer_load_dwordx4 v30, s[92:95], s96 offen nt lds
    s_add_u32 s96, s96, 1024
    s_mov_b32 m0, s96
    v_xor_b32 v30, 192, v31
    buffer_load_dwordx4 v30, s[92:95], s96 offen nt lds
    s_add_u32 s96, s96, 1024
    s_mov_b32 m0, s96
    v_xor_b32 v30, 16, v31
    buffer_load_dwordx4 v30, s[92:95], s96 offen nt lds
    s_add_u32 s96, s96, 1024
    s_mov_b32 m0, s96
    v_xor_b32 v30, 80, v31
    buffer_load_dwordx4 v30, s[92:95], s96 offen nt lds
    s_add_u32 s96, s96, 1024
    s_mov_b32 m0, s96
    v_xor_b32 v30, 144, v31
    buffer_load_dwordx4 v30, s[92:95], s96 offen nt lds
    s_add_u32 s96, s96, 1024
    s_mov_b32 m0, s96
    v_xor_b32 v30, 208, v31
    buffer_load_dwordx4 v30, s[92:95], s96 offen nt lds
    s_add_u32 s96, s96, 1024
    s_mov_b32 m0, s96
    v_xor_b32 v30, 32, v31
    buffer_load_dwordx4 v30, s[92:95], s96 offen nt lds
    s_add_u32 s96, s96, 1024
    s_mov_b32 m0, s96
    v_xor_b32 v30, 96, v31
    buffer_load_dwordx4 v30, s[92:95], s96 offen nt lds
    s_add_u32 s96, s96, 1024
    s_mov_b32 m0, s96
    v_xor_b32 v30, 160, v31
    buffer_load_dwordx4 v30, s[92:95], s96 offen nt lds
    s_add_u32 s96, s96, 1024
    s_mov_b32 m0, s96
    v_xor_b32 v30, 224, v31
    buffer_load_dwordx4 v30, s[92:95], s96 offen nt lds
    s_add_u32 s96, s96, 1024
    s_mov_b32 m0, s96
    v_xor_b32 v30, 48, v31
    buffer_load_dwordx4 v30, s[92:95], s96 offen nt lds
    s_add_u32 s96, s96, 1024
    s_mov_b32 m0, s96
    v_xor_b32 v30, 112, v31
    buffer_load_dwordx4 v30, s[92:95], s96 offen nt lds
    s_add_u32 s96, s96, 1024
    s_mov_b32 m0, s96
    v_xor_b32 v30, 176, v31
    buffer_load_dwordx4 v30, s[92:95], s96 offen nt lds
    s_add_u32 s96, s96, 1024
    s_mov_b32 m0, s96
    v_xor_b32 v30, 240, v31
    buffer_load_dwordx4 v30, s[92:95], s96 offen nt lds
    s_add_u32 s96, s96, 1024
    s_mov_b32 m0, s96
    v_xor_b32 v30, 0, v31
    buffer_load_dwordx4 v30, s[92:95], s96 offen nt lds
    s_add_u32 s96, s96, 1024
    s_mov_b32 m0, s96
    v_xor_b32 v30, 64, v31
    buffer_load_dwordx4 v30, s[92:95], s96 offen nt lds
    s_add_u32 s96, s96, 1024
    s_mov_b32 m0, s96
    v_xor_b32 v30, 128, v31
    buffer_load_dwordx4 v30, s[92:95], s96 offen nt lds
    s_add_u32 s96, s96, 1024
    s_mov_b32 m0, s96
    v_xor_b32 v30, 192, v31
    buffer_load_dwordx4 v30, s[92:95], s96 offen nt lds
    s_add_u32 s96, s96, 1024
    s_mov_b32 m0, s96
    v_xor_b32 v30, 16, v31
    buffer_load_dwordx4 v30, s[92:95], s96 offen nt lds
    s_add_u32 s96, s96, 1024
    s_mov_b32 m0, s96
    v_xor_b32 v30, 80, v31
    buffer_load_dwordx4 v30, s[92:95], s96 offen nt lds
    s_add_u32 s96, s96, 1024
    s_mov_b32 m0, s96
    v_xor_b32 v30, 144, v31
    buffer_load_dwordx4 v30, s[92:95], s96 offen nt lds
    s_add_u32 s96, s96, 1024
    s_mov_b32 m0, s96
    v_xor_b32 v30, 208, v31
    buffer_load_dwordx4 v30, s[92:95], s96 offen nt lds
    s_add_u32 s96, s96, 1024
    s_mov_b32 m0, s96
    v_xor_b32 v30, 32, v31
    buffer_load_dwordx4 v30, s[92:95], s96 offen nt lds
    s_add_u32 s96, s96, 1024
    s_mov_b32 m0, s96
    v_xor_b32 v30, 96, v31
    buffer_load_dwordx4 v30, s[92:95], s96 offen nt lds
    s_add_u32 s96, s96, 1024
    s_mov_b32 m0, s96
    v_xor_b32 v30, 160, v31
    buffer_load_dwordx4 v30, s[92:95], s96 offen nt lds
    s_add_u32 s96, s96, 1024
    s_mov_b32 m0, s96
    v_xor_b32 v30, 224, v31
    buffer_load_dwordx4 v30, s[92:95], s96 offen nt lds
    s_add_u32 s96, s96, 1024
    s_mov_b32 m0, s96
    v_xor_b32 v30, 48, v31
    buffer_load_dwordx4 v30, s[92:95], s96 offen nt lds
    s_add_u32 s96, s96, 1024
    s_mov_b32 m0, s96
    v_xor_b32 v30, 112, v31
    buffer_load_dwordx4 v30, s[92:95], s96 offen nt lds
    s_add_u32 s96, s96, 1024
    s_mov_b32 m0, s96
    v_xor_b32 v30, 176, v31
    buffer_load_dwordx4 v30, s[92:95], s96 offen nt lds
    s_add_u32 s96, s96, 1024
    s_mov_b32 m0, s96
    v_xor_b32 v30, 240, v31
    buffer_load_dwordx4 v30, s[92:95], s96 offen nt lds
    s_add_u32 s96, s96, 1024
    s_branch L_DMA_D
L_S1:
    s_lshr_b32 s5, s3, 1
    s_and_b32 s6, s3, 1
    s_mov_b32 s48, s20
    s_mov_b32 s49, s21
    s_mov_b32 s50, 5242880
    s_mov_b32 s51, 0x20000
    s_mov_b32 s52, s16
    s_mov_b32 s53, s17
    s_mov_b32 s54, 1280
    s_mov_b32 s55, 0x20000
    v_mul_u32_u24 v21, 20, v1
    buffer_load_dwordx4 v[124:127], v21, s[52:55], 0 offen
    buffer_load_dword v128, v21, s[52:55], 0 offen offset:16
    v_lshlrev_b32 v21, 3, v0
    buffer_load_dwordx2 v[130:131], v21, s[52:55], 0 offen
    v_and_b32 v20, 1, v0
    v_lshlrev_b32 v20, 4, v20
    v_mov_b32 v21, 0xffff
    v_lshlrev_b32 v21, v20, v21
    v_bfe_u32 v22, v0, 1, 2
    v_cmp_eq_u32 vcc, 0, v22
    s_nop 1
    v_cndmask_b32 v4, 0, v21, vcc
    v_cmp_eq_u32 vcc, 1, v22
    s_nop 1
    v_cndmask_b32 v5, 0, v21, vcc
    v_cmp_eq_u32 vcc, 2, v22
    s_nop 1
    v_cndmask_b32 v6, 0, v21, vcc
    v_cmp_eq_u32 vcc, 3, v22
    s_nop 1
    v_cndmask_b32 v7, 0, v21, vcc
    v_lshrrev_b32 v24, 3, v2
    v_lshl_add_u32 v24, v24, 2, v3
    v_mul_u32_u24 v24, 20, v24
    s_mul_i32 s8, s4, 160
    v_add_u32 v24, s8, v24
    v_lshlrev_b32 v23, 13, v24
    v_and_b32 v21, 7, v2
    v_lshlrev_b32 v21, 4, v21
    s_lshl_b32 s10, s5, 8
    s_lshl_b32 s11, s6, 7
    s_add_u32 s10, s10, s11
    v_add3_u32 v23, v23, v21, s10
    s_mov_b32 s12, 0
    buffer_load_dwordx4 v[32:35], v23, s[48:51], s12 offen nt
    s_mov_b32 s12, 8192
    buffer_load_dwordx4 v[36:39], v23, s[48:51], s12 offen nt
    s_mov_b32 s12, 16384
    buffer_load_dwordx4 v[40:43], v23, s[48:51], s12 offen nt
    s_mov_b32 s12, 24576
    buffer_load_dwordx4 v[44:47], v23, s[48:51], s12 offen nt
    s_mov_b32 s12, 32768
    buffer_load_dwordx4 v[48:51], v23, s[48:51], s12 offen nt
    s_mov_b32 s12, 40960
    buffer_load_dwordx4 v[52:55], v23, s[48:51], s12 offen nt
    s_mov_b32 s12, 49152
    buffer_load_dwordx4 v[56:59], v23, s[48:51], s12 offen nt
    s_mov_b32 s12, 57344
    buffer_load_dwordx4 v[60:63], v23, s[48:51], s12 offen nt
    s_mov_b32 s12, 65536
    buffer_load_dwordx4 v[64:67], v23, s[48:51], s12 offen nt
    s_mov_b32 s12, 73728
    buffer_load_dwordx4 v[68:71], v23, s[48:51], s12 offen nt
    s_mov_b32 s12, 81920
    buffer_load_dwordx4 v[72:75], v23, s[48:51], s12 offen nt
    s_mov_b32 s12, 90112
    buffer_load_dwordx4 v[76:79], v23, s[48:51], s12 offen nt
    s_mov_b32 s12, 98304
    buffer_load_dwordx4 v[80:83], v23, s[48:51], s12 offen nt
    s_mov_b32 s12, 106496
    buffer_load_dwordx4 v[84:87], v23, s[48:51], s12 offen nt
    s_mov_b32 s12, 114688
    buffer_load_dwordx4 v[88:91], v23, s[48:51], s12 offen nt
    s_mov_b32 s12, 122880
    buffer_load_dwordx4 v[92:95], v23, s[48:51], s12 offen nt
    s_mov_b32 s12, 131072
    buffer_load_dwordx4 v[96:99], v23, s[48:51], s12 offen nt
    s_mov_b32 s12, 139264
    buffer_load_dwordx4 v[100:103], v23, s[48:51], s12 offen nt
    s_mov_b32 s12, 147456
    buffer_load_dwordx4 v[104:107], v23, s[48:51], s12 offen nt
    s_mov_b32 s12, 155648
    buffer_load_dwordx4 v[108:111], v23, s[48:51], s12 offen nt
    s_lshl_b32 s8, s3, 17
    s_add_u32 s92, s18, s8
    s_addc_u32 s93, s19, 0
    s_mov_b32 s94, 131072
    s_mov_b32 s95, 0x20000
    v_lshlrev_b32 v19, 4, v1
    s_lshl_b32 s96, s4, 15
    v_lshlrev_b32 v31, 4, v1
    s_waitcnt vmcnt(20)
    v_lshlrev_b32 v132, 16, v124
    v_and_b32 v133, 0xffff0000, v124
    v_lshlrev_b32 v134, 16, v125
    v_and_b32 v135, 0xffff0000, v125
    v_lshlrev_b32 v136, 16, v126
    v_and_b32 v137, 0xffff0000, v126
    v_lshlrev_b32 v138, 16, v127
    v_and_b32 v139, 0xffff0000, v127
    v_lshlrev_b32 v140, 16, v128
    v_and_b32 v141, 0xffff0000, v128
    v_add_f32 v20, v132, v133
    v_add_f32 v20, v20, v134
    v_add_f32 v20, v20, v135
    v_add_f32 v20, v20, v136
    v_add_f32 v20, v20, v137
    v_add_f32 v20, v20, v138
    v_add_f32 v20, v20, v139
    v_add_f32 v20, v20, v140
    v_add_f32 v20, v20, v141
    s_nop 1
    v_add_f32_dpp v20, v20, v20 row_shr:1 row_mask:0xf bank_mask:0xf bound_ctrl:0
    s_nop 1
    v_add_f32_dpp v20, v20, v20 row_shr:2 row_mask:0xf bank_mask:0xf bound_ctrl:0
    s_nop 1
    v_add_f32_dpp v20, v20, v20 row_shr:4 row_mask:0xf bank_mask:0xf bound_ctrl:0
    s_nop 1
    v_add_f32_dpp v20, v20, v20 row_shr:8 row_mask:0xf bank_mask:0xf bound_ctrl:0
    s_nop 1
    v_add_f32_dpp v20, v20, v20 row_bcast:15 row_mask:0xa bank_mask:0xf
    s_nop 1
    v_add_f32_dpp v20, v20, v20 row_bcast:31 row_mask:0xc bank_mask:0xf
    s_nop 0
    v_readlane_b32 s8, v20, 63
    s_nop 1
    v_mov_b32 v21, s8
    v_mul_f32 v21, 0x3acccccd, v21
    v_mov_b32 v20, 0
    v_sub_f32 v22, v132, v21
    v_fmac_f32 v20, v22, v22
    v_sub_f32 v22, v133, v21
    v_fmac_f32 v20, v22, v22
    v_sub_f32 v22, v134, v21
    v_fmac_f32 v20, v22, v22
    v_sub_f32 v22, v135, v21
    v_fmac_f32 v20, v22, v22
    v_sub_f32 v22, v136, v21
    v_fmac_f32 v20, v22, v22
    v_sub_f32 v22, v137, v21
    v_fmac_f32 v20, v22, v22
    v_sub_f32 v22, v138, v21
    v_fmac_f32 v20, v22, v22
    v_sub_f32 v22, v139, v21
    v_fmac_f32 v20, v22, v22
    v_sub_f32 v22, v140, v21
    v_fmac_f32 v20, v22, v22
    v_sub_f32 v22, v141, v21
    v_fmac_f32 v20, v22, v22
    s_nop 1
    v_add_f32_dpp v20, v20, v20 row_shr:1 row_mask:0xf bank_mask:0xf bound_ctrl:0
    s_nop 1
    v_add_f32_dpp v20, v20, v20 row_shr:2 row_mask:0xf bank_mask:0xf bound_ctrl:0
    s_nop 1
    v_add_f32_dpp v20, v20, v20 row_shr:4 row_mask:0xf bank_mask:0xf bound_ctrl:0
    s_nop 1
    v_add_f32_dpp v20, v20, v20 row_shr:8 row_mask:0xf bank_mask:0xf bound_ctrl:0
    s_nop 1
    v_add_f32_dpp v20, v20, v20 row_bcast:15 row_mask:0xa bank_mask:0xf
    s_nop 1
    v_add_f32_dpp v20, v20, v20 row_bcast:31 row_mask:0xc bank_mask:0xf
    s_nop 0
    v_readlane_b32 s8, v20, 63
    s_nop 1
    v_mov_b32 v22, s8
    v_mul_f32 v22, 0x3acccccd, v22
    v_add_f32 v22, 0x3727c5ac, v22
    v_rsq_f32 v22, v22
    s_nop 0
    v_lshlrev_b32 v132, 16, v130
    v_and_b32 v133, 0xffff0000, v130
    v_lshlrev_b32 v134, 16, v131
    v_and_b32 v135, 0xffff0000, v131
    v_sub_f32 v132, v132, v21
    v_mul_f32 v132, v132, v22
    v_sub_f32 v133, v133, v21
    v_mul_f32 v133, v133, v22
    v_sub_f32 v134, v134, v21
    v_mul_f32 v134, v134, v22
    v_sub_f32 v135, v135, v21
    v_mul_f32 v135, v135, v22
    s_waitcnt lgkmcnt(0)
    s_mul_i32 s8, s42, 0x9e3779b1
    s_add_u32 s97, s8, 0x7f4a7c15
    s_and_b32 s42, s97, 0xbfffbfff
    v_cmp_gt_u32 vcc, 160, v0
    s_and_saveexec_b64 s[14:15], vcc
    s_cbranch_execz L_6
    v_lshlrev_b32 v20, 4, v0
    s_mov_b32 s8, 4096
    s_mov_b32 s9, 6656
    s_mov_b32 s10, 20480
    s_mov_b32 s11, 23040
    buffer_load_dwordx4 v[144:147], v20, s[44:47], s8 offen sc1
    buffer_load_dwordx4 v[148:151], v20, s[44:47], s10 offen sc1
    buffer_load_dwordx4 v[152:155], v20, s[44:47], s9 offen sc1
    buffer_load_dwordx4 v[156:159], v20, s[44:47], s11 offen sc1
    buffer_load_dwordx4 v[160:163], v20, s[44:47], s8 offen sc1
    buffer_load_dwordx4 v[164:167], v20, s[44:47], s10 offen sc1
    buffer_load_dwordx4 v[168:171], v20, s[44:47], s9 offen sc1
    buffer_load_dwordx4 v[172:175], v20, s[44:47], s11 offen sc1
P_7:
    s_waitcnt vmcnt(4)
    v_sad_u32 v30, v145, s42, 0
    v_sad_u32 v30, v147, s42, v30
    v_sad_u32 v30, v149, s42, v30
    v_sad_u32 v30, v151, s42, v30
    v_sad_u32 v30, v153, s42, v30
    v_sad_u32 v30, v155, s42, v30
    v_sad_u32 v30, v157, s42, v30
    v_sad_u32 v30, v159, s42, v30
    v_cmp_ne_u32 vcc, 0, v30
    s_cbranch_vccz PK_9
    s_sub_u32 s59, s59, 1
    s_cbranch_scc1 L_END
    buffer_load_dwordx4 v[144:147], v20, s[44:47], s8 offen sc1
    buffer_load_dwordx4 v[148:151], v20, s[44:47], s10 offen sc1
    buffer_load_dwordx4 v[152:155], v20, s[44:47], s9 offen sc1
    buffer_load_dwordx4 v[156:159], v20, s[44:47], s11 offen sc1
    s_waitcnt vmcnt(4)
    v_sad_u32 v30, v161, s42, 0
    v_sad_u32 v30, v163, s42, v30
    v_sad_u32 v30, v165, s42, v30
    v_sad_u32 v30, v167, s42, v30
    v_sad_u32 v30, v169, s42, v30
    v_sad_u32 v30, v171, s42, v30
    v_sad_u32 v30, v173, s42, v30
    v_sad_u32 v30, v175, s42, v30
    v_cmp_ne_u32 vcc, 0, v30
    s_cbranch_vccz PK_10
    buffer_load_dwordx4 v[160:163], v20, s[44:47], s8 offen sc1
    buffer_load_dwordx4 v[164:167], v20, s[44:47], s10 offen sc1
    buffer_load_dwordx4 v[168:171], v20, s[44:47], s9 offen sc1
    buffer_load_dwordx4 v[172:175], v20, s[44:47], s11 offen sc1
    s_branch P_7
PK_10:
    v_mov_b32 v176, v160
    v_mov_b32 v177, v162
    v_mov_b32 v178, v164
    v_mov_b32 v179, v166
    v_mov_b32 v180, v168
    v_mov_b32 v181, v170
    v_mov_b32 v182, v172
    v_mov_b32 v183, v174
    s_branch PD_8
PK_9:
    v_mov_b32 v176, v144
    v_mov_b32 v177, v146
    v_mov_b32 v178, v148
    v_mov_b32 v179, v150
    v_mov_b32 v180, v152
    v_mov_b32 v181, v154
    v_mov_b32 v182, v156
    v_mov_b32 v183, v158
PD_8:
    v_lshlrev_b32 v8, 16, v176
    v_and_b32 v9, 0xffff0000, v176
    v_lshlrev_b32 v10, 16, v177
    v_and_b32 v11, 0xffff0000, v177
    v_lshlrev_b32 v12, 16, v178
    v_and_b32 v13, 0xffff0000, v178
    v_lshlrev_b32 v14, 16, v179
    v_and_b32 v15, 0xffff0000, v179
    v_pk_add_f32 v[8:9], v[8:9], v[12:13]
    v_pk_add_f32 v[10:11], v[10:11], v[14:15]
    v_lshlrev_b32 v12, 16, v180
    v_and_b32 v13, 0xffff0000, v180
    v_lshlrev_b32 v14, 16, v181
    v_and_b32 v15, 0xffff0000, v181
    v_lshlrev_b32 v16, 16, v182
    v_and_b32 v17, 0xffff0000, v182
    v_lshlrev_b32 v18, 16, v183
    v_and_b32 v19, 0xffff0000, v183
    v_pk_add_f32 v[12:13], v[12:13], v[16:17]
    v_pk_add_f32 v[14:15], v[14:15], v[18:19]
    v_pk_fma_f32 v[8:9], v[132:133], v[12:13], v[8:9]
    v_pk_fma_f32 v[10:11], v[134:135], v[14:15], v[10:11]
    v_pk_add_f32 v[8:9], v[8:9], v[132:133]
    v_pk_add_f32 v[10:11], v[10:11], v[134:135]
    v_cvt_pk_bf16_f32 v26, v8, v9
    v_cvt_pk_bf16_f32 v27, v10, v11
    v_perm_b32 v28, v26, v26, s56
    v_perm_b32 v29, v26, v26, s57
    v_perm_b32 v30, v27, v27, s56
    v_perm_b32 v31, v27, v27, s57
    v_add_u32 v21, 131072, v20
    ds_write_b128 v21, v[28:31]
L_6:
    s_mov_b64 exec, s[14:15]
    s_waitcnt lgkmcnt(0)
    s_barrier
    v_lshlrev_b32 v21, 2, v24
    v_add_u32 v21, 131072, v21
    ds_read_b64 v[192:193], v21 offset:0
    ds_read_b64 v[194:195], v21 offset:8
    ds_read_b64 v[196:197], v21 offset:16
    ds_read_b64 v[198:199], v21 offset:24
    ds_read_b64 v[200:201], v21 offset:32
    ds_read_b64 v[202:203], v21 offset:40
    ds_read_b64 v[204:205], v21 offset:48
    ds_read_b64 v[206:207], v21 offset:56
    ds_read_b64 v[208:209], v21 offset:64
    ds_read_b64 v[210:211], v21 offset:72
    v_lshrrev_b32 v20, 3, v2
    v_lshrrev_b32 v21, 1, v3
    v_cmp_eq_u32 s[12:13], v20, v21
    s_lshl_b32 s8, s4, 1
    v_add_u32 v20, s8, v20
    v_lshlrev_b32 v20, 8, v20
    v_and_b32 v21, 7, v2
    v_lshlrev_b32 v21, 5, v21
    v_and_b32 v22, 1, v3
    v_lshlrev_b32 v22, 4, v22
    v_add3_u32 v20, v20, v21, v22
    v_add_u32 v20, 135168, v20
    s_waitcnt vmcnt(0) lgkmcnt(0)
    v_and_b32 v8, v192, v4
    v_and_b32 v9, v192, v5
    v_and_b32 v10, v192, v6
    v_and_b32 v11, v192, v7
    v_and_b32 v12, v193, v4
    v_and_b32 v13, v193, v5
    v_and_b32 v14, v193, v6
    v_and_b32 v15, v193, v7
    v_mfma_f32_16x16x32_bf16 v[16:19], v[8:11], v[32:35], 0
    v_and_b32 v8, v194, v4
    v_and_b32 v9, v194, v5
    v_and_b32 v10, v194, v6
    v_and_b32 v11, v194, v7
    v_mfma_f32_16x16x32_bf16 v[16:19], v[12:15], v[36:39], v[16:19]
    v_and_b32 v12, v195, v4
    v_and_b32 v13, v195, v5
    v_and_b32 v14, v195, v6
    v_and_b32 v15, v195, v7
    v_mfma_f32_16x16x32_bf16 v[16:19], v[8:11], v[40:43], v[16:19]
    v_and_b32 v8, v196, v4
    v_and_b32 v9, v196, v5
    v_and_b32 v10, v196, v6
    v_and_b32 v11, v196, v7
    v_mfma_f32_16x16x32_bf16 v[16:19], v[12:15], v[44:47], v[16:19]
    v_and_b32 v12, v197, v4
    v_and_b32 v13, v197, v5
    v_and_b32 v14, v197, v6
    v_and_b32 v15, v197, v7
    v_mfma_f32_16x16x32_bf16 v[16:19], v[8:11], v[48:51], v[16:19]
    v_and_b32 v8, v198, v4
    v_and_b32 v9, v198, v5
    v_and_b32 v10, v198, v6
    v_and_b32 v11, v198, v7
    v_mfma_f32_16x16x32_bf16 v[16:19], v[12:15], v[52:55], v[16:19]
    v_and_b32 v12, v199, v4
    v_and_b32 v13, v199, v5
    v_and_b32 v14, v199, v6
    v_and_b32 v15, v199, v7
    v_mfma_f32_16x16x32_bf16 v[16:19], v[8:11], v[56:59], v[16:19]
    v_and_b32 v8, v200, v4
    v_and_b32 v9, v200, v5
    v_and_b32 v10, v200, v6
    v_and_b32 v11, v200, v7
    v_mfma_f32_16x16x32_bf16 v[16:19], v[12:15], v[60:63], v[16:19]
    v_and_b32 v12, v201, v4
    v_and_b32 v13, v201, v5
    v_and_b32 v14, v201, v6
    v_and_b32 v15, v201, v7
    v_mfma_f32_16x16x32_bf16 v[16:19], v[8:11], v[64:67], v[16:19]
    v_and_b32 v8, v202, v4
    v_and_b32 v9, v202, v5
    v_and_b32 v10, v202, v6
    v_and_b32 v11, v202, v7
    v_mfma_f32_16x16x32_bf16 v[16:19], v[12:15], v[68:71], v[16:19]
    v_and_b32 v12, v203, v4
    v_and_b32 v13, v203, v5
    v_and_b32 v14, v203, v6
    v_and_b32 v15, v203, v7
    v_mfma_f32_16x16x32_bf16 v[16:19], v[8:11], v[72:75], v[16:19]
    v_and_b32 v8, v204, v4
    v_and_b32 v9, v204, v5
    v_and_b32 v10, v204, v6
    v_and_b32 v11, v204, v7
    v_mfma_f32_16x16x32_bf16 v[16:19], v[12:15], v[76:79], v[16:19]
    v_and_b32 v12, v205, v4
    v_and_b32 v13, v205, v5
    v_and_b32 v14, v205, v6
    v_and_b32 v15, v205, v7
    v_mfma_f32_16x16x32_bf16 v[16:19], v[8:11], v[80:83], v[16:19]
    v_and_b32 v8, v206, v4
    v_and_b32 v9, v206, v5
    v_and_b32 v10, v206, v6
    v_and_b32 v11, v206, v7
    v_mfma_f32_16x16x32_bf16 v[16:19], v[12:15], v[84:87], v[16:19]
    v_and_b32 v12, v207, v4
    v_and_b32 v13, v207, v5
    v_and_b32 v14, v207, v6
    v_and_b32 v15, v207, v7
    v_mfma_f32_16x16x32_bf16 v[16:19], v[8:11], v[88:91], v[16:19]
    v_and_b32 v8, v208, v4
    v_and_b32 v9, v208, v5
    v_and_b32 v10, v208, v6
    v_and_b32 v11, v208, v7
    v_mfma_f32_16x16x32_bf16 v[16:19], v[12:15], v[92:95], v[16:19]
    v_and_b32 v12, v209, v4
    v_and_b32 v13, v209, v5
    v_and_b32 v14, v209, v6
    v_and_b32 v15, v209, v7
    v_mfma_f32_16x16x32_bf16 v[16:19], v[8:11], v[96:99], v[16:19]
    v_and_b32 v8, v210, v4
    v_and_b32 v9, v210, v5
    v_and_b32 v10, v210, v6
    v_and_b32 v11, v210, v7
    v_mfma_f32_16x16x32_bf16 v[16:19], v[12:15], v[100:103], v[16:19]
    v_and_b32 v12, v211, v4
    v_and_b32 v13, v211, v5
    v_and_b32 v14, v211, v6
    v_and_b32 v15, v211, v7
    v_mfma_f32_16x16x32_bf16 v[16:19], v[8:11], v[104:107], v[16:19]
    s_nop 1
    v_mfma_f32_16x16x32_bf16 v[16:19], v[12:15], v[108:111], v[16:19]
    s_nop 7
    s_mov_b64 s[14:15], exec
    s_mov_b64 exec, s[12:13]
    ds_write_b128 v20, v[16:19]
    s_mov_b64 exec, s[14:15]
    s_waitcnt lgkmcnt(0)
    s_barrier
    v_cmp_gt_u32 vcc, 64, v0
    s_and_saveexec_b64 s[14:15], vcc
    s_cbranch_execz L_11
    v_lshlrev_b32 v20, 2, v0
    v_add_u32 v20, 135168, v20
    ds_read_b32 v192, v20 offset:0
    ds_read_b32 v193, v20 offset:256
    ds_read_b32 v194, v20 offset:512
    ds_read_b32 v195, v20 offset:768
    ds_read_b32 v196, v20 offset:1024
    ds_read_b32 v197, v20 offset:1280
    ds_read_b32 v198, v20 offset:1536
    ds_read_b32 v199, v20 offset:1792
    s_lshl_b32 s8, s5, 10
    s_lshl_b32 s9, s6, 9
    s_add_u32 s8, s8, s9
    s_add_u32 s8, s8, 65536
    v_mov_b32 v23, s42
    v_lshlrev_b32 v20, 3, v0
    s_waitcnt lgkmcnt(0)
    v_pk_add_f32 v[192:193], v[192:193], v[196:197]
    v_pk_add_f32 v[194:195], v[194:195], v[198:199]
    v_pk_add_f32 v[192:193], v[192:193], v[194:195]
    v_add_f32 v22, v192, v193
    buffer_store_dwordx2 v[22:23], v20, s[44:47], s8 offen sc1
L_11:
    s_mov_b64 exec, s[14:15]
    v_lshlrev_b32 v31, 4, v1
    s_mov_b32 m0, s96
    v_xor_b32 v30, 0, v31
    buffer_load_dwordx4 v30, s[92:95], s96 offen nt lds
    s_add_u32 s96, s96, 1024
    s_mov_b32 m0, s96
    v_xor_b32 v30, 64, v31
    buffer_load_dwordx4 v30, s[92:95], s96 offen nt lds
    s_add_u32 s96, s96, 1024
    s_mov_b32 m0, s96
    v_xor_b32 v30, 128, v31
    buffer_load_dwordx4 v30, s[92:95], s96 offen nt lds
    s_add_u32 s96, s96, 1024
    s_mov_b32 m0, s96
    v_xor_b32 v30, 192, v31
    buffer_load_dwordx4 v30, s[92:95], s96 offen nt lds
    s_add_u32 s96, s96, 1024
    s_mov_b32 m0, s96
    v_xor_b32 v30, 16, v31
    buffer_load_dwordx4 v30, s[92:95], s96 offen nt lds
    s_add_u32 s96, s96, 1024
    s_mov_b32 m0, s96
    v_xor_b32 v30, 80, v31
    buffer_load_dwordx4 v30, s[92:95], s96 offen nt lds
    s_add_u32 s96, s96, 1024
    s_mov_b32 m0, s96
    v_xor_b32 v30, 144, v31
    buffer_load_dwordx4 v30, s[92:95], s96 offen nt lds
    s_add_u32 s96, s96, 1024
    s_mov_b32 m0, s96
    v_xor_b32 v30, 208, v31
    buffer_load_dwordx4 v30, s[92:95], s96 offen nt lds
    s_add_u32 s96, s96, 1024
    s_mov_b32 m0, s96
    v_xor_b32 v30, 32, v31
    buffer_load_dwordx4 v30, s[92:95], s96 offen nt lds
    s_add_u32 s96, s96, 1024
    s_mov_b32 m0, s96
    v_xor_b32 v30, 96, v31
    buffer_load_dwordx4 v30, s[92:95], s96 offen nt lds
    s_add_u32 s96, s96, 1024
    s_mov_b32 m0, s96
    v_xor_b32 v30, 160, v31
    buffer_load_dwordx4 v30, s[92:95], s96 offen nt lds
    s_add_u32 s96, s96, 1024
    s_mov_b32 m0, s96
    v_xor_b32 v30, 224, v31
    buffer_load_dwordx4 v30, s[92:95], s96 offen nt lds
    s_add_u32 s96, s96, 1024
    s_mov_b32 m0, s96
    v_xor_b32 v30, 48, v31
    buffer_load_dwordx4 v30, s[92:95], s96 offen nt lds
    s_add_u32 s96, s96, 1024
    s_mov_b32 m0, s96
    v_xor_b32 v30, 112, v31
    buffer_load_dwordx4 v30, s[92:95], s96 offen nt lds
    s_add_u32 s96, s96, 1024
    s_mov_b32 m0, s96
    v_xor_b32 v30, 176, v31
    buffer_load_dwordx4 v30, s[92:95], s96 offen nt lds
    s_add_u32 s96, s96, 1024
    s_mov_b32 m0, s96
    v_xor_b32 v30, 240, v31
    buffer_load_dwordx4 v30, s[92:95], s96 offen nt lds
    s_add_u32 s96, s96, 1024
    s_mov_b32 m0, s96
    v_xor_b32 v30, 0, v31
    buffer_load_dwordx4 v30, s[92:95], s96 offen nt lds
    s_add_u32 s96, s96, 1024
    s_mov_b32 m0, s96
    v_xor_b32 v30, 64, v31
    buffer_load_dwordx4 v30, s[92:95], s96 offen nt lds
    s_add_u32 s96, s96, 1024
    s_mov_b32 m0, s96
    v_xor_b32 v30, 128, v31
    buffer_load_dwordx4 v30, s[92:95], s96 offen nt lds
    s_add_u32 s96, s96, 1024
    s_mov_b32 m0, s96
    v_xor_b32 v30, 192, v31
    buffer_load_dwordx4 v30, s[92:95], s96 offen nt lds
    s_add_u32 s96, s96, 1024
    s_mov_b32 m0, s96
    v_xor_b32 v30, 16, v31
    buffer_load_dwordx4 v30, s[92:95], s96 offen nt lds
    s_add_u32 s96, s96, 1024
    s_mov_b32 m0, s96
    v_xor_b32 v30, 80, v31
    buffer_load_dwordx4 v30, s[92:95], s96 offen nt lds
    s_add_u32 s96, s96, 1024
    s_mov_b32 m0, s96
    v_xor_b32 v30, 144, v31
    buffer_load_dwordx4 v30, s[92:95], s96 offen nt lds
    s_add_u32 s96, s96, 1024
    s_mov_b32 m0, s96
    v_xor_b32 v30, 208, v31
    buffer_load_dwordx4 v30, s[92:95], s96 offen nt lds
    s_add_u32 s96, s96, 1024
    s_mov_b32 m0, s96
    v_xor_b32 v30, 32, v31
    buffer_load_dwordx4 v30, s[92:95], s96 offen nt lds
    s_add_u32 s96, s96, 1024
    s_mov_b32 m0, s96
    v_xor_b32 v30, 96, v31
    buffer_load_dwordx4 v30, s[92:95], s96 offen nt lds
    s_add_u32 s96, s96, 1024
    s_mov_b32 m0, s96
    v_xor_b32 v30, 160, v31
    buffer_load_dwordx4 v30, s[92:95], s96 offen nt lds
    s_add_u32 s96, s96, 1024
    s_mov_b32 m0, s96
    v_xor_b32 v30, 224, v31
    buffer_load_dwordx4 v30, s[92:95], s96 offen nt lds
    s_add_u32 s96, s96, 1024
    s_mov_b32 m0, s96
    v_xor_b32 v30, 48, v31
    buffer_load_dwordx4 v30, s[92:95], s96 offen nt lds
    s_add_u32 s96, s96, 1024
    s_mov_b32 m0, s96
    v_xor_b32 v30, 112, v31
    buffer_load_dwordx4 v30, s[92:95], s96 offen nt lds
    s_add_u32 s96, s96, 1024
    s_mov_b32 m0, s96
    v_xor_b32 v30, 176, v31
    buffer_load_dwordx4 v30, s[92:95], s96 offen nt lds
    s_add_u32 s96, s96, 1024
    s_mov_b32 m0, s96
    v_xor_b32 v30, 240, v31
    buffer_load_dwordx4 v30, s[92:95], s96 offen nt lds
    s_add_u32 s96, s96, 1024
    s_branch L_DMA_D
L_S2ONLY:
    v_and_b32 v20, 1, v0
    v_lshlrev_b32 v20, 4, v20
    v_mov_b32 v21, 0xffff
    v_lshlrev_b32 v21, v20, v21
    v_bfe_u32 v22, v0, 1, 2
    v_cmp_eq_u32 vcc, 0, v22
    s_nop 1
    v_cndmask_b32 v4, 0, v21, vcc
    v_cmp_eq_u32 vcc, 1, v22
    s_nop 1
    v_cndmask_b32 v5, 0, v21, vcc
    v_cmp_eq_u32 vcc, 2, v22
    s_nop 1
    v_cndmask_b32 v6, 0, v21, vcc
    v_cmp_eq_u32 vcc, 3, v22
    s_nop 1
    v_cndmask_b32 v7, 0, v21, vcc
    s_waitcnt lgkmcnt(0)
    s_mul_i32 s8, s42, 0x9e3779b1
    s_add_u32 s97, s8, 0x7f4a7c15
    s_and_b32 s42, s97, 0xbfffbfff
    s_sub_u32 s8, s3, 128
    s_lshr_b32 s8, s8, 2
    s_and_b32 s9, s3, 3
    s_mov_b32 s52, s22
    s_mov_b32 s53, s23
    s_mov_b32 s54, 4194304
    s_mov_b32 s55, 0x20000
    s_lshl_b32 s9, s9, 7
    s_lshl_b32 s10, s4, 5
    s_add_u32 s9, s9, s10
    v_add_u32 v20, s9, v2
    v_lshlrev_b32 v20, 13, v20
    v_lshlrev_b32 v21, 4, v3
    s_lshl_b32 s10, s8, 8
    v_add3_u32 v20, v20, v21, s10
    s_mov_b32 s12, 0
    buffer_load_dwordx4 v[72:75], v20, s[52:55], s12 offen offset:0 nt
    buffer_load_dwordx4 v[76:79], v20, s[52:55], s12 offen offset:64 nt
    buffer_load_dwordx4 v[80:83], v20, s[52:55], s12 offen offset:128 nt
    buffer_load_dwordx4 v[84:87], v20, s[52:55], s12 offen offset:192 nt
    s_mov_b32 s12, 131072
    buffer_load_dwordx4 v[88:91], v20, s[52:55], s12 offen offset:0 nt
    buffer_load_dwordx4 v[92:95], v20, s[52:55], s12 offen offset:64 nt
    buffer_load_dwordx4 v[96:99], v20, s[52:55], s12 offen offset:128 nt
    buffer_load_dwordx4 v[100:103], v20, s[52:55], s12 offen offset:192 nt
    s_lshl_b32 s8, s3, 17
    s_add_u32 s92, s18, s8
    s_addc_u32 s93, s19, 0
    s_mov_b32 s94, 131072
    s_mov_b32 s95, 0x20000
    v_lshlrev_b32 v19, 4, v1
    s_lshl_b32 s96, s4, 15
    s_waitcnt vmcnt(0)
    v_lshlrev_b32 v31, 4, v1
    s_mov_b32 m0, s96
    v_xor_b32 v30, 0, v31
    buffer_load_dwordx4 v30, s[92:95], s96 offen nt lds
    s_add_u32 s96, s96, 1024
    s_mov_b32 m0, s96
    v_xor_b32 v30, 64, v31
    buffer_load_dwordx4 v30, s[92:95], s96 offen nt lds
    s_add_u32 s96, s96, 1024
    s_mov_b32 m0, s96
    v_xor_b32 v30, 128, v31
    buffer_load_dwordx4 v30, s[92:95], s96 offen nt lds
    s_add_u32 s96, s96, 1024
    s_mov_b32 m0, s96
    v_xor_b32 v30, 192, v31
    buffer_load_dwordx4 v30, s[92:95], s96 offen nt lds
    s_add_u32 s96, s96, 1024
    s_mov_b32 m0, s96
    v_xor_b32 v30, 16, v31
    buffer_load_dwordx4 v30, s[92:95], s96 offen nt lds
    s_add_u32 s96, s96, 1024
    s_mov_b32 m0, s96
    v_xor_b32 v30, 80, v31
    buffer_load_dwordx4 v30, s[92:95], s96 offen nt lds
    s_add_u32 s96, s96, 1024
    s_mov_b32 m0, s96
    v_xor_b32 v30, 144, v31
    buffer_load_dwordx4 v30, s[92:95], s96 offen nt lds
    s_add_u32 s96, s96, 1024
    s_mov_b32 m0, s96
    v_xor_b32 v30, 208, v31
    buffer_load_dwordx4 v30, s[92:95], s96 offen nt lds
    s_add_u32 s96, s96, 1024
    s_mov_b32 m0, s96
    v_xor_b32 v30, 32, v31
    buffer_load_dwordx4 v30, s[92:95], s96 offen nt lds
    s_add_u32 s96, s96, 1024
    s_mov_b32 m0, s96
    v_xor_b32 v30, 96, v31
    buffer_load_dwordx4 v30, s[92:95], s96 offen nt lds
    s_add_u32 s96, s96, 1024
    s_mov_b32 m0, s96
    v_xor_b32 v30, 160, v31
    buffer_load_dwordx4 v30, s[92:95], s96 offen nt lds
    s_add_u32 s96, s96, 1024
    s_mov_b32 m0, s96
    v_xor_b32 v30, 224, v31
    buffer_load_dwordx4 v30, s[92:95], s96 offen nt lds
    s_add_u32 s96, s96, 1024
    s_mov_b32 m0, s96
    v_xor_b32 v30, 48, v31
    buffer_load_dwordx4 v30, s[92:95], s96 offen nt lds
    s_add_u32 s96, s96, 1024
    s_mov_b32 m0, s96
    v_xor_b32 v30, 112, v31
    buffer_load_dwordx4 v30, s[92:95], s96 offen nt lds
    s_add_u32 s96, s96, 1024
    s_mov_b32 m0, s96
    v_xor_b32 v30, 176, v31
    buffer_load_dwordx4 v30, s[92:95], s96 offen nt lds
    s_add_u32 s96, s96, 1024
    s_mov_b32 m0, s96
    v_xor_b32 v30, 240, v31
    buffer_load_dwordx4 v30, s[92:95], s96 offen nt lds
    s_add_u32 s96, s96, 1024
    s_mov_b32 m0, s96
    v_xor_b32 v30, 0, v31
    buffer_load_dwordx4 v30, s[92:95], s96 offen nt lds
    s_add_u32 s96, s96, 1024
    s_mov_b32 m0, s96
    v_xor_b32 v30, 64, v31
    buffer_load_dwordx4 v30, s[92:95], s96 offen nt lds
    s_add_u32 s96, s96, 1024
    s_mov_b32 m0, s96
    v_xor_b32 v30, 128, v31
    buffer_load_dwordx4 v30, s[92:95], s96 offen nt lds
    s_add_u32 s96, s96, 1024
    s_mov_b32 m0, s96
    v_xor_b32 v30, 192, v31
    buffer_load_dwordx4 v30, s[92:95], s96 offen nt lds
    s_add_u32 s96, s96, 1024
    s_mov_b32 m0, s96
    v_xor_b32 v30, 16, v31
    buffer_load_dwordx4 v30, s[92:95], s96 offen nt lds
    s_add_u32 s96, s96, 1024
    s_mov_b32 m0, s96
    v_xor_b32 v30, 80, v31
    buffer_load_dwordx4 v30, s[92:95], s96 offen nt lds
    s_add_u32 s96, s96, 1024
    s_sub_u32 s5, s3, 128
    s_lshr_b32 s5, s5, 2
    s_and_b32 s6, s3, 3
    v_cmp_gt_u32 vcc, 128, v0
    s_and_saveexec_b64 s[14:15], vcc
    s_cbranch_execz L_14
    v_lshlrev_b32 v20, 3, v0
    s_lshl_b32 s8, s5, 10
    s_add_u32 s8, s8, 65536
    buffer_load_dwordx2 v[140:141], v20, s[44:47], s8 offen sc1
    buffer_load_dwordx2 v[142:143], v20, s[44:47], s8 offen sc1
    buffer_load_dwordx2 v[144:145], v20, s[44:47], s8 offen sc1
P_15:
    s_waitcnt vmcnt(2)
    v_sad_u32 v30, v141, s42, 0
    v_cmp_ne_u32 vcc, 0, v30
    s_cbranch_vccz PK_17
    s_sub_u32 s59, s59, 1
    s_cbranch_scc1 L_END
    s_sleep 1
    buffer_load_dwordx2 v[140:141], v20, s[44:47], s8 offen sc1
    s_waitcnt vmcnt(2)
    v_sad_u32 v30, v143, s42, 0
    v_cmp_ne_u32 vcc, 0, v30
    s_cbranch_vccz PK_18
    s_sleep 1
    buffer_load_dwordx2 v[142:143], v20, s[44:47], s8 offen sc1
    s_waitcnt vmcnt(2)
    v_sad_u32 v30, v145, s42, 0
    v_cmp_ne_u32 vcc, 0, v30
    s_cbranch_vccz PK_19
    s_sleep 1
    buffer_load_dwordx2 v[144:145], v20, s[44:47], s8 offen sc1
    s_branch P_15
PK_19:
    v_mov_b32 v136, v144
    s_branch PD_16
PK_18:
    v_mov_b32 v136, v142
    s_branch PD_16
PK_17:
    v_mov_b32 v136, v140
PD_16:
    v_cvt_pk_bf16_f32 v136, v136, v136
    v_lshlrev_b32 v21, 1, v0
    v_add_u32 v21, 131072, v21
    ds_write_b16 v21, v136
L_14:
    s_mov_b64 exec, s[14:15]
    s_waitcnt lgkmcnt(0)
    s_barrier
    v_lshlrev_b32 v21, 4, v3
    v_add_u32 v21, 131072, v21
    ds_read_b128 v[192:195], v21 offset:0
    ds_read_b128 v[196:199], v21 offset:64
    ds_read_b128 v[200:203], v21 offset:128
    ds_read_b128 v[204:207], v21 offset:192
    s_lshl_b32 s8, s6, 3
    s_lshl_b32 s9, s4, 1
    s_add_u32 s8, s8, s9
    s_lshl_b32 s8, s8, 10
    s_lshl_b32 s9, s5, 4
    s_add_u32 s8, s8, s9
    s_add_u32 s8, s8, 163840
    v_lshlrev_b32 v20, 10, v2
    v_lshrrev_b32 v21, 1, v3
    v_lshlrev_b32 v21, 9, v21
    v_and_b32 v24, 1, v3
    v_lshlrev_b32 v24, 3, v24
    v_add3_u32 v20, v20, v21, v24
    v_cmp_eq_u32 s[10:11], 1, v2
    s_mov_b32 s9, 0x3e0293ee
    s_waitcnt vmcnt(22) lgkmcnt(0)
    v_mfma_f32_16x16x32_bf16 v[208:211], v[72:75], v[192:195], 0
    v_mfma_f32_16x16x32_bf16 v[212:215], v[88:91], v[192:195], 0
    v_mfma_f32_16x16x32_bf16 v[208:211], v[76:79], v[196:199], v[208:211]
    v_mfma_f32_16x16x32_bf16 v[212:215], v[92:95], v[196:199], v[212:215]
    v_mfma_f32_16x16x32_bf16 v[208:211], v[80:83], v[200:203], v[208:211]
    v_mfma_f32_16x16x32_bf16 v[212:215], v[96:99], v[200:203], v[212:215]
    v_mfma_f32_16x16x32_bf16 v[208:211], v[84:87], v[204:207], v[208:211]
    v_mfma_f32_16x16x32_bf16 v[212:215], v[100:103], v[204:207], v[212:215]
    s_nop 7
    v_cndmask_b32 v208, v208, v212, s[10:11]
    v_cndmask_b32 v209, v209, v213, s[10:11]
    v_cndmask_b32 v210, v210, v214, s[10:11]
    v_cndmask_b32 v211, v211, v215, s[10:11]
    v_mul_f32 v208, s9, v208
    v_mul_f32 v209, s9, v209
    v_mul_f32 v210, s9, v210
    v_mul_f32 v211, s9, v211
    v_cvt_pk_bf16_f32 v22, v208, v209
    v_cvt_pk_bf16_f32 v23, v210, v211
    v_cmp_gt_u32 vcc, 2, v2
    s_and_saveexec_b64 s[14:15], vcc
    buffer_store_dwordx2 v[22:23], v20, s[44:47], s8 offen sc1
    s_mov_b64 exec, s[14:15]
    s_waitcnt vmcnt(0)
    s_barrier
    v_cmp_gt_u32 vcc, 8, v0
    s_and_saveexec_b64 s[14:15], vcc
    s_cbranch_execz L_20
    v_lshlrev_b32 v20, 11, v0
    s_sub_u32 s8, s3, 128
    s_lshl_b32 s8, s8, 4
    s_add_u32 s8, s8, 131072
    v_mov_b32 v22, s42
    buffer_store_dword v22, v20, s[44:47], s8 offen sc1
L_20:
    s_mov_b64 exec, s[14:15]
    v_lshlrev_b32 v31, 4, v1
    s_mov_b32 m0, s96
    v_xor_b32 v30, 144, v31
    buffer_load_dwordx4 v30, s[92:95], s96 offen nt lds
    s_add_u32 s96, s96, 1024
    s_mov_b32 m0, s96
    v_xor_b32 v30, 208, v31
    buffer_load_dwordx4 v30, s[92:95], s96 offen nt lds
    s_add_u32 s96, s96, 1024
    s_mov_b32 m0, s96
    v_xor_b32 v30, 32, v31
    buffer_load_dwordx4 v30, s[92:95], s96 offen nt lds
    s_add_u32 s96, s96, 1024
    s_mov_b32 m0, s96
    v_xor_b32 v30, 96, v31
    buffer_load_dwordx4 v30, s[92:95], s96 offen nt lds
    s_add_u32 s96, s96, 1024
    s_mov_b32 m0, s96
    v_xor_b32 v30, 160, v31
    buffer_load_dwordx4 v30, s[92:95], s96 offen nt lds
    s_add_u32 s96, s96, 1024
    s_mov_b32 m0, s96
    v_xor_b32 v30, 224, v31
    buffer_load_dwordx4 v30, s[92:95], s96 offen nt lds
    s_add_u32 s96, s96, 1024
    s_mov_b32 m0, s96
    v_xor_b32 v30, 48, v31
    buffer_load_dwordx4 v30, s[92:95], s96 offen nt lds
    s_add_u32 s96, s96, 1024
    s_mov_b32 m0, s96
    v_xor_b32 v30, 112, v31
    buffer_load_dwordx4 v30, s[92:95], s96 offen nt lds
    s_add_u32 s96, s96, 1024
    s_mov_b32 m0, s96
    v_xor_b32 v30, 176, v31
    buffer_load_dwordx4 v30, s[92:95], s96 offen nt lds
    s_add_u32 s96, s96, 1024
    s_mov_b32 m0, s96
    v_xor_b32 v30, 240, v31
    buffer_load_dwordx4 v30, s[92:95], s96 offen nt lds
    s_add_u32 s96, s96, 1024
    s_branch L_DMA_D
L_DMA_D:
    v_lshlrev_b32 v21, 4, v1
    v_and_b32 v20, 31, v1
    v_lshrrev_b32 v22, 5, v1
    v_and_b32 v23, 3, v20
    v_lshlrev_b32 v23, 2, v23
    v_bfe_u32 v24, v20, 2, 2
    v_or_b32 v23, v23, v24
    v_xor_b32 v23, v23, v22
    v_lshlrev_b32 v23, 4, v23
    s_lshl_b32 s8, s4, 15
    v_lshlrev_b32 v24, 10, v20
    v_add3_u32 v23, v23, v24, s8
    v_xor_b32 v224, 0, v23
    v_xor_b32 v225, 32, v23
    v_xor_b32 v226, 64, v23
    v_xor_b32 v227, 96, v23
    v_xor_b32 v228, 128, v23
    v_xor_b32 v229, 160, v23
    v_xor_b32 v230, 192, v23
    v_xor_b32 v231, 224, v23
    v_lshlrev_b32 v232, 4, v1
    v_add_u32 v232, 131072, v232
    s_waitcnt vmcnt(0)
    ds_read_b128 a[0:3], v224 offset:0
    ds_read_b128 a[4:7], v225 offset:0
    ds_read_b128 a[8:11], v226 offset:0
    ds_read_b128 a[12:15], v227 offset:0
    ds_read_b128 a[16:19], v228 offset:0
    ds_read_b128 a[20:23], v229 offset:0
    ds_read_b128 a[24:27], v230 offset:0
    ds_read_b128 a[28:31], v231 offset:0
    ds_read_b128 a[32:35], v224 offset:256
    ds_read_b128 a[36:39], v225 offset:256
    ds_read_b128 a[40:43], v226 offset:256
    ds_read_b128 a[44:47], v227 offset:256
    ds_read_b128 a[48:51], v228 offset:256
    s_waitcnt lgkmcnt(12)
    ds_read_b128 a[52:55], v229 offset:256
    s_waitcnt lgkmcnt(12)
    ds_read_b128 a[56:59], v230 offset:256
    s_waitcnt lgkmcnt(12)
    ds_read_b128 a[60:63], v231 offset:256
    s_waitcnt lgkmcnt(12)
    ds_read_b128 a[64:67], v224 offset:512
    s_waitcnt lgkmcnt(12)
    ds_read_b128 a[68:71], v225 offset:512
    s_waitcnt lgkmcnt(12)
    ds_read_b128 a[72:75], v226 offset:512
    s_waitcnt lgkmcnt(12)
    ds_read_b128 a[76:79], v227 offset:512
    s_waitcnt lgkmcnt(12)
    ds_read_b128 a[80:83], v228 offset:512
    s_waitcnt lgkmcnt(12)
    ds_read_b128 a[84:87], v229 offset:512
    s_waitcnt lgkmcnt(12)
    ds_read_b128 a[88:91], v230 offset:512
    s_waitcnt lgkmcnt(12)
    ds_read_b128 a[92:95], v231 offset:512
    s_waitcnt lgkmcnt(12)
    ds_read_b128 a[96:99], v224 offset:768
    s_waitcnt lgkmcnt(12)
    ds_read_b128 a[100:103], v225 offset:768
    s_waitcnt lgkmcnt(12)
    ds_read_b128 a[104:107], v226 offset:768
    s_waitcnt lgkmcnt(12)
    ds_read_b128 a[108:111], v227 offset:768
    s_waitcnt lgkmcnt(12)
    ds_read_b128 a[112:115], v228 offset:768
    s_waitcnt lgkmcnt(12)
    ds_read_b128 a[116:119], v229 offset:768
    s_waitcnt lgkmcnt(12)
    ds_read_b128 a[120:123], v230 offset:768
    s_waitcnt lgkmcnt(12)
    ds_read_b128 a[124:127], v231 offset:768
    s_waitcnt lgkmcnt(12)
    s_cmp_lg_u32 s4, 0
    s_cbranch_scc1 L_E3D
    s_and_b32 s8, s3, 7
    s_lshl_b32 s8, s8, 11
    s_add_u32 s8, s8, 131072
    buffer_load_dword v26, v21, s[44:47], s8 offen sc1
    buffer_load_dword v27, v21, s[44:47], s8 offen offset:1024 sc1
    buffer_load_dword v28, v21, s[44:47], s8 offen sc1
    buffer_load_dword v29, v21, s[44:47], s8 offen offset:1024 sc1
P_22:
    s_waitcnt vmcnt(2)
    v_sad_u32 v30, v26, s42, 0
    v_sad_u32 v30, v27, s42, v30
    v_cmp_ne_u32 vcc, 0, v30
    s_cbranch_vccz PK_24
    s_sub_u32 s59, s59, 1
    s_cbranch_scc1 L_END
    s_sleep 1
    buffer_load_dword v26, v21, s[44:47], s8 offen sc1
    buffer_load_dword v27, v21, s[44:47], s8 offen offset:1024 sc1
    s_waitcnt vmcnt(2)
    v_sad_u32 v30, v28, s42, 0
    v_sad_u32 v30, v29, s42, v30
    v_cmp_ne_u32 vcc, 0, v30
    s_cbranch_vccz PK_25
    s_sleep 1
    buffer_load_dword v28, v21, s[44:47], s8 offen sc1
    buffer_load_dword v29, v21, s[44:47], s8 offen offset:1024 sc1
    s_branch P_22
PK_25:
    s_branch PD_23
PK_24:
PD_23:
L_E3D:
    s_barrier
    s_mov_b32 s9, 163840
    buffer_load_dwordx4 a[224:227], v21, s[44:47], s9 offen sc1
    s_lshl_b32 s8, s4, 13
    s_add_u32 s8, s8, 163840
    buffer_load_dwordx4 a[192:195], v21, s[44:47], s8 offen offset:0 sc1
    buffer_load_dwordx4 a[196:199], v21, s[44:47], s8 offen offset:1024 sc1
    buffer_load_dwordx4 a[200:203], v21, s[44:47], s8 offen offset:2048 sc1
    buffer_load_dwordx4 a[204:207], v21, s[44:47], s8 offen offset:3072 sc1
    s_add_u32 s8, s8, 4096
    buffer_load_dwordx4 a[208:211], v21, s[44:47], s8 offen offset:0 sc1
    buffer_load_dwordx4 a[212:215], v21, s[44:47], s8 offen offset:1024 sc1
    buffer_load_dwordx4 a[216:219], v21, s[44:47], s8 offen offset:2048 sc1
    buffer_load_dwordx4 a[220:223], v21, s[44:47], s8 offen offset:3072 sc1
    s_lshl_b32 s8, s4, 13
    v_add_u32 v25, s8, v232
    s_cmp_lt_u32 s3, 128
    s_cbranch_scc1 L_NOUV
    s_mov_b32 s48, s24
    s_mov_b32 s49, s25
    s_mov_b32 s50, 4194304
    s_mov_b32 s51, 0x20000
    s_and_b32 s8, s3, 3
    s_lshl_b32 s8, s8, 7
    s_lshl_b32 s9, s4, 5
    s_add_u32 s8, s8, s9
    v_lshrrev_b32 v20, 1, v3
    v_lshlrev_b32 v20, 4, v20
    v_and_b32 v22, 1, v3
    v_lshlrev_b32 v22, 2, v22
    v_add3_u32 v20, v20, v22, s8
    v_lshlrev_b32 v20, 13, v20
    v_lshlrev_b32 v22, 4, v2
    s_sub_u32 s9, s3, 128
    s_lshr_b32 s9, s9, 2
    s_lshl_b32 s9, s9, 8
    v_add3_u32 v20, v20, v22, s9
    s_mov_b32 s12, 0
    buffer_load_dwordx4 v[32:35], v20, s[48:51], s12 offen nt
    s_mov_b32 s12, 8192
    buffer_load_dwordx4 v[36:39], v20, s[48:51], s12 offen nt
    s_mov_b32 s12, 16384
    buffer_load_dwordx4 v[40:43], v20, s[48:51], s12 offen nt
    s_mov_b32 s12, 24576
    buffer_load_dwordx4 v[44:47], v20, s[48:51], s12 offen nt
    s_mov_b32 s12, 65536
    buffer_load_dwordx4 v[48:51], v20, s[48:51], s12 offen nt
    s_mov_b32 s12, 73728
    buffer_load_dwordx4 v[52:55], v20, s[48:51], s12 offen nt
    s_mov_b32 s12, 81920
    buffer_load_dwordx4 v[56:59], v20, s[48:51], s12 offen nt
    s_mov_b32 s12, 90112
    buffer_load_dwordx4 v[60:63], v20, s[48:51], s12 offen nt
    s_waitcnt vmcnt(8)
    s_branch L_UVD
L_NOUV:
    s_waitcnt vmcnt(0)
L_UVD:
    ds_write_b128 v25, a[192:195] offset:0
    ds_write_b128 v25, a[196:199] offset:1024
    ds_write_b128 v25, a[200:203] offset:2048
    ds_write_b128 v25, a[204:207] offset:3072
    ds_write_b128 v25, a[208:211] offset:4096
    ds_write_b128 v25, a[212:215] offset:5120
    ds_write_b128 v25, a[216:219] offset:6144
    ds_write_b128 v25, a[220:223] offset:7168
    s_waitcnt lgkmcnt(0)
    s_barrier
    ds_read_b128 a[164:167], v232 offset:1024
    ds_read_b128 a[168:171], v232 offset:2048
    ds_read_b128 a[172:175], v232 offset:3072
    ds_read_b128 a[176:179], v232 offset:4096
    ds_read_b128 a[180:183], v232 offset:5120
    ds_read_b128 a[184:187], v232 offset:6144
    v_mfma_f32_32x32x16_bf16 v[208:223], a[0:3], a[224:227], 0
    ds_read_b128 a[188:191], v232 offset:7168
    s_waitcnt lgkmcnt(6)
    v_mfma_f32_32x32x16_bf16 v[208:223], a[4:7], a[164:167], v[208:223]
    ds_read_b128 a[160:163], v232 offset:8192
    s_waitcnt lgkmcnt(6)
    v_mfma_f32_32x32x16_bf16 v[208:223], a[8:11], a[168:171], v[208:223]
    ds_read_b128 a[164:167], v232 offset:9216
    s_waitcnt lgkmcnt(6)
    v_mfma_f32_32x32x16_bf16 v[208:223], a[12:15], a[172:175], v[208:223]
    ds_read_b128 a[168:171], v232 offset:10240
    s_waitcnt lgkmcnt(6)
    v_mfma_f32_32x32x16_bf16 v[208:223], a[16:19], a[176:179], v[208:223]
    ds_read_b128 a[172:175], v232 offset:11264
    s_waitcnt lgkmcnt(6)
    v_mfma_f32_32x32x16_bf16 v[208:223], a[20:23], a[180:183], v[208:223]
    ds_read_b128 a[176:179], v232 offset:12288
    s_waitcnt lgkmcnt(6)
    v_mfma_f32_32x32x16_bf16 v[208:223], a[24:27], a[184:187], v[208:223]
    ds_read_b128 a[180:183], v232 offset:13312
    s_waitcnt lgkmcnt(6)
    v_mfma_f32_32x32x16_bf16 v[208:223], a[28:31], a[188:191], v[208:223]
    ds_read_b128 a[184:187], v232 offset:14336
    s_waitcnt lgkmcnt(6)
    v_mfma_f32_32x32x16_bf16 v[208:223], a[32:35], a[160:163], v[208:223]
    ds_read_b128 a[188:191], v232 offset:15360
    s_waitcnt lgkmcnt(6)
    v_mfma_f32_32x32x16_bf16 v[208:223], a[36:39], a[164:167], v[208:223]
    ds_read_b128 a[160:163], v232 offset:16384
    s_waitcnt lgkmcnt(6)
    v_mfma_f32_32x32x16_bf16 v[208:223], a[40:43], a[168:171], v[208:223]
    ds_read_b128 a[164:167], v232 offset:17408
    s_waitcnt lgkmcnt(6)
    v_mfma_f32_32x32x16_bf16 v[208:223], a[44:47], a[172:175], v[208:223]
    ds_read_b128 a[168:171], v232 offset:18432
    s_waitcnt lgkmcnt(6)
    v_mfma_f32_32x32x16_bf16 v[208:223], a[48:51], a[176:179], v[208:223]
    ds_read_b128 a[172:175], v232 offset:19456
    s_waitcnt lgkmcnt(6)
    v_mfma_f32_32x32x16_bf16 v[208:223], a[52:55], a[180:183], v[208:223]
    ds_read_b128 a[176:179], v232 offset:20480
    s_waitcnt lgkmcnt(6)
    v_mfma_f32_32x32x16_bf16 v[208:223], a[56:59], a[184:187], v[208:223]
    ds_read_b128 a[180:183], v232 offset:21504
    s_waitcnt lgkmcnt(6)
    v_mfma_f32_32x32x16_bf16 v[208:223], a[60:63], a[188:191], v[208:223]
    ds_read_b128 a[184:187], v232 offset:22528
    s_waitcnt lgkmcnt(6)
    v_mfma_f32_32x32x16_bf16 v[208:223], a[64:67], a[160:163], v[208:223]
    ds_read_b128 a[188:191], v232 offset:23552
    s_waitcnt lgkmcnt(6)
    v_mfma_f32_32x32x16_bf16 v[208:223], a[68:71], a[164:167], v[208:223]
    ds_read_b128 a[160:163], v232 offset:24576
    s_waitcnt lgkmcnt(6)
    v_mfma_f32_32x32x16_bf16 v[208:223], a[72:75], a[168:171], v[208:223]
    ds_read_b128 a[164:167], v232 offset:25600
    s_waitcnt lgkmcnt(6)
    v_mfma_f32_32x32x16_bf16 v[208:223], a[76:79], a[172:175], v[208:223]
    ds_read_b128 a[168:171], v232 offset:26624
    s_waitcnt lgkmcnt(6)
    v_mfma_f32_32x32x16_bf16 v[208:223], a[80:83], a[176:179], v[208:223]
    ds_read_b128 a[172:175], v232 offset:27648
    s_waitcnt lgkmcnt(6)
    v_mfma_f32_32x32x16_bf16 v[208:223], a[84:87], a[180:183], v[208:223]
    ds_read_b128 a[176:179], v232 offset:28672
    s_waitcnt lgkmcnt(6)
    v_mfma_f32_32x32x16_bf16 v[208:223], a[88:91], a[184:187], v[208:223]
    ds_read_b128 a[180:183], v232 offset:29696
    s_waitcnt lgkmcnt(6)
    v_mfma_f32_32x32x16_bf16 v[208:223], a[92:95], a[188:191], v[208:223]
    ds_read_b128 a[184:187], v232 offset:30720
    s_waitcnt lgkmcnt(6)
    v_mfma_f32_32x32x16_bf16 v[208:223], a[96:99], a[160:163], v[208:223]
    ds_read_b128 a[188:191], v232 offset:31744
    s_waitcnt lgkmcnt(6)
    v_mfma_f32_32x32x16_bf16 v[208:223], a[100:103], a[164:167], v[208:223]
    s_waitcnt lgkmcnt(5)
    v_mfma_f32_32x32x16_bf16 v[208:223], a[104:107], a[168:171], v[208:223]
    s_waitcnt lgkmcnt(4)
    v_mfma_f32_32x32x16_bf16 v[208:223], a[108:111], a[172:175], v[208:223]
    s_waitcnt lgkmcnt(3)
    v_mfma_f32_32x32x16_bf16 v[208:223], a[112:115], a[176:179], v[208:223]
    s_waitcnt lgkmcnt(2)
    v_mfma_f32_32x32x16_bf16 v[208:223], a[116:119], a[180:183], v[208:223]
    s_waitcnt lgkmcnt(1)
    v_mfma_f32_32x32x16_bf16 v[208:223], a[120:123], a[184:187], v[208:223]
    s_waitcnt lgkmcnt(0)
    v_mfma_f32_32x32x16_bf16 v[208:223], a[124:127], a[188:191], v[208:223]
    v_bfe_u32 v20, v1, 2, 2
    v_lshrrev_b32 v22, 5, v1
    v_bfe_u32 v23, v1, 4, 1
    v_bfe_u32 v24, v1, 1, 1
    v_lshl_or_b32 v23, v23, 1, v24
    v_xor_b32 v23, v23, v22
    v_lshl_or_b32 v23, v20, 2, v23
    v_lshlrev_b32 v23, 4, v23
    v_and_b32 v24, 1, v1
    v_lshlrev_b32 v24, 3, v24
    v_lshlrev_b32 v25, 2, v22
    v_add_u32 v25, v25, v20
    v_lshlrev_b32 v25, 10, v25
    s_lshl_b32 s8, s4, 8
    v_add3_u32 v23, v23, v24, v25
    v_add_u32 v23, s8, v23
    v_xor_b32 v224, 0, v23
    v_xor_b32 v228, 32, v23
    v_add_u32 v228, 8192, v228
    v_xor_b32 v225, 64, v23
    v_xor_b32 v229, 96, v23
    v_add_u32 v229, 8192, v229
    v_xor_b32 v226, 128, v23
    v_xor_b32 v230, 160, v23
    v_add_u32 v230, 8192, v230
    v_xor_b32 v227, 192, v23
    v_xor_b32 v231, 224, v23
    v_add_u32 v231, 8192, v231
    v_max3_f32 v26, v208, v209, v210
    v_max3_f32 v26, v26, v211, v212
    v_max3_f32 v26, v26, v213, v214
    v_max3_f32 v26, v26, v215, v216
    v_max3_f32 v26, v26, v217, v218
    v_max3_f32 v26, v26, v219, v220
    v_max3_f32 v26, v26, v221, v222
    v_max_f32 v26, v26, v223
    v_mov_b32 v27, v26
    s_nop 1
    v_permlane32_swap_b32 v26, v27
    s_nop 0
    v_max_f32 v26, v26, v27
    v_and_b32 v20, 31, v1
    v_lshlrev_b32 v20, 2, v20
    v_add_u32 v20, 131072, v20
    s_lshl_b32 s8, s4, 7
    v_add_u32 v22, s8, v20
    ds_write_b32 v22, v26
    s_waitcnt lgkmcnt(0)
    s_barrier
    ds_read_b32 v28, v20 offset:0
    ds_read_b32 v29, v20 offset:128
    ds_read_b32 v30, v20 offset:256
    ds_read_b32 v31, v20 offset:384
    s_lshl_b32 s8, s4, 11
    s_add_u32 s8, s8, 8192
    v_add_u32 v23, s8, v232
    s_waitcnt lgkmcnt(0)
    v_max3_f32 v26, v28, v29, v30
    v_max_f32 v26, v26, v31
    v_mov_b32 v27, v26
    s_nop 0
    v_pk_add_f32 v[208:209], v[208:209], v[26:27] neg_lo:[0,1] neg_hi:[0,1]
    v_pk_add_f32 v[210:211], v[210:211], v[26:27] neg_lo:[0,1] neg_hi:[0,1]
    v_pk_add_f32 v[212:213], v[212:213], v[26:27] neg_lo:[0,1] neg_hi:[0,1]
    v_pk_add_f32 v[214:215], v[214:215], v[26:27] neg_lo:[0,1] neg_hi:[0,1]
    v_pk_add_f32 v[216:217], v[216:217], v[26:27] neg_lo:[0,1] neg_hi:[0,1]
    v_pk_add_f32 v[218:219], v[218:219], v[26:27] neg_lo:[0,1] neg_hi:[0,1]
    v_pk_add_f32 v[220:221], v[220:221], v[26:27] neg_lo:[0,1] neg_hi:[0,1]
    v_pk_add_f32 v[222:223], v[222:223], v[26:27] neg_lo:[0,1] neg_hi:[0,1]
    v_exp_f32 v208, v208
    v_exp_f32 v209, v209
    v_exp_f32 v210, v210
    v_exp_f32 v211, v211
    v_exp_f32 v212, v212
    v_exp_f32 v213, v213
    v_exp_f32 v214, v214
    v_exp_f32 v215, v215
    v_exp_f32 v216, v216
    v_exp_f32 v217, v217
    v_exp_f32 v218, v218
    v_exp_f32 v219, v219
    v_exp_f32 v220, v220
    v_exp_f32 v221, v221
    v_exp_f32 v222, v222
    v_exp_f32 v223, v223
    v_pk_add_f32 v[28:29], v[208:209], v[210:211]
    v_pk_add_f32 v[30:31], v[212:213], v[214:215]
    v_pk_add_f32 v[28:29], v[28:29], v[216:217]
    v_pk_add_f32 v[30:31], v[30:31], v[218:219]
    v_pk_add_f32 v[28:29], v[28:29], v[220:221]
    v_pk_add_f32 v[30:31], v[30:31], v[222:223]
    v_cvt_pk_bf16_f32 v208, v208, v209
    v_cvt_pk_bf16_f32 v209, v210, v211
    v_cvt_pk_bf16_f32 v210, v212, v213
    v_cvt_pk_bf16_f32 v211, v214, v215
    v_cvt_pk_bf16_f32 v212, v216, v217
    v_cvt_pk_bf16_f32 v213, v218, v219
    v_cvt_pk_bf16_f32 v214, v220, v221
    v_cvt_pk_bf16_f32 v215, v222, v223
    v_pk_add_f32 v[28:29], v[28:29], v[30:31]
    ds_write_b128 v23, v[208:211]
    ds_write_b128 v23, v[212:215] offset:1024
    v_add_f32 v27, v28, v29
    v_mov_b32 v28, v27
    s_nop 1
    v_permlane32_swap_b32 v27, v28
    s_nop 0
    v_add_f32 v27, v27, v28
    ds_write_b32 v22, v27 offset:512
    s_waitcnt lgkmcnt(0)
    s_barrier
    ds_read_b128 a[96:99], v232 offset:8192
    ds_read_b128 a[100:103], v232 offset:9216
    ds_read_b128 a[104:107], v232 offset:10240
    ds_read_b128 a[108:111], v232 offset:11264
    ds_read_b128 a[112:115], v232 offset:12288
    ds_read_b128 a[116:119], v232 offset:13312
    ds_read_b128 a[120:123], v232 offset:14336
    ds_read_b128 a[124:127], v232 offset:15360
    ds_read_b32 v28, v20 offset:512
    ds_read_b32 v29, v20 offset:640
    ds_read_b32 v30, v20 offset:768
    ds_read_b32 v31, v20 offset:896
    s_waitcnt lgkmcnt(0)
    s_barrier
    v_add_f32 v27, v28, v29
    v_add_f32 v27, v27, v30
    v_add_f32 v27, v27, v31
    v_and_b32 v20, 31, v1
    v_lshrrev_b32 v22, 5, v1
    v_and_b32 v23, 15, v20
    v_xor_b32 v23, v23, v22
    v_lshlrev_b32 v23, 4, v23
    v_lshlrev_b32 v24, 8, v20
    s_lshl_b32 s8, s4, 13
    s_add_u32 s8, s8, 131072
    v_add3_u32 v23, v23, v24, s8
    v_lshrrev_b32 v24, 3, v1
    v_and_b32 v25, 7, v1
    v_xor_b32 v20, v24, v25
    v_lshlrev_b32 v20, 4, v20
    v_lshl_add_u32 v20, v24, 8, v20
    v_add_u32 v20, s8, v20
    v_lshlrev_b32 v22, 18, v24
    v_lshl_add_u32 v22, v25, 4, v22
    s_lshl_b32 s9, s3, 8
    s_add_u32 s9, s9, 1048576
    s_lshl_b32 s10, s4, 16
    s_add_u32 s9, s9, s10
    ds_read_b64_tr_b16 a[128:129], v224 offset:0
    ds_read_b64_tr_b16 a[130:131], v228 offset:0
    ds_read_b64_tr_b16 a[132:133], v225 offset:0
    ds_read_b64_tr_b16 a[134:135], v229 offset:0
    ds_read_b64_tr_b16 a[136:137], v224 offset:16384
    ds_read_b64_tr_b16 a[138:139], v228 offset:16384
    ds_read_b64_tr_b16 a[140:141], v225 offset:16384
    ds_read_b64_tr_b16 a[142:143], v229 offset:16384
    ds_read_b64_tr_b16 a[144:145], v224 offset:32768
    ds_read_b64_tr_b16 a[146:147], v228 offset:32768
    s_waitcnt lgkmcnt(8)
    v_mfma_f32_32x32x16_bf16 v[128:143], a[128:131], a[96:99], 0
    ds_read_b64_tr_b16 a[148:149], v225 offset:32768
    ds_read_b64_tr_b16 a[150:151], v229 offset:32768
    s_waitcnt lgkmcnt(8)
    v_mfma_f32_32x32x16_bf16 v[144:159], a[132:135], a[96:99], 0
    ds_read_b64_tr_b16 a[152:153], v224 offset:49152
    ds_read_b64_tr_b16 a[154:155], v228 offset:49152
    s_waitcnt lgkmcnt(8)
    v_mfma_f32_32x32x16_bf16 v[128:143], a[136:139], a[100:103], v[128:143]
    ds_read_b64_tr_b16 a[156:157], v225 offset:49152
    ds_read_b64_tr_b16 a[158:159], v229 offset:49152
    s_waitcnt lgkmcnt(8)
    v_mfma_f32_32x32x16_bf16 v[144:159], a[140:143], a[100:103], v[144:159]
    v_add_u32 v224, 0x10000, v224
    v_add_u32 v228, 0x10000, v228
    v_add_u32 v225, 0x10000, v225
    v_add_u32 v229, 0x10000, v229
    ds_read_b64_tr_b16 a[128:129], v224 offset:0
    ds_read_b64_tr_b16 a[130:131], v228 offset:0
    s_waitcnt lgkmcnt(8)
    v_mfma_f32_32x32x16_bf16 v[128:143], a[144:147], a[104:107], v[128:143]
    ds_read_b64_tr_b16 a[132:133], v225 offset:0
    ds_read_b64_tr_b16 a[134:135], v229 offset:0
    s_waitcnt lgkmcnt(8)
    v_mfma_f32_32x32x16_bf16 v[144:159], a[148:151], a[104:107], v[144:159]
    ds_read_b64_tr_b16 a[136:137], v224 offset:16384
    ds_read_b64_tr_b16 a[138:139], v228 offset:16384
    s_waitcnt lgkmcnt(8)
    v_mfma_f32_32x32x16_bf16 v[128:143], a[152:155], a[108:111], v[128:143]
    ds_read_b64_tr_b16 a[140:141], v225 offset:16384
    ds_read_b64_tr_b16 a[142:143], v229 offset:16384
    s_waitcnt lgkmcnt(8)
    v_mfma_f32_32x32x16_bf16 v[144:159], a[156:159], a[108:111], v[144:159]
    ds_read_b64_tr_b16 a[144:145], v224 offset:32768
    ds_read_b64_tr_b16 a[146:147], v228 offset:32768
    s_waitcnt lgkmcnt(8)
    v_mfma_f32_32x32x16_bf16 v[128:143], a[128:131], a[112:115], v[128:143]
    ds_read_b64_tr_b16 a[148:149], v225 offset:32768
    ds_read_b64_tr_b16 a[150:151], v229 offset:32768
    s_waitcnt lgkmcnt(8)
    v_mfma_f32_32x32x16_bf16 v[144:159], a[132:135], a[112:115], v[144:159]
    ds_read_b64_tr_b16 a[152:153], v224 offset:49152
    ds_read_b64_tr_b16 a[154:155], v228 offset:49152
    s_waitcnt lgkmcnt(8)
    v_mfma_f32_32x32x16_bf16 v[128:143], a[136:139], a[116:119], v[128:143]
    ds_read_b64_tr_b16 a[156:157], v225 offset:49152
    ds_read_b64_tr_b16 a[158:159], v229 offset:49152
    s_waitcnt lgkmcnt(8)
    v_mfma_f32_32x32x16_bf16 v[144:159], a[140:143], a[116:119], v[144:159]
    ds_read_b64_tr_b16 a[128:129], v226 offset:0
    ds_read_b64_tr_b16 a[130:131], v230 offset:0
    s_waitcnt lgkmcnt(8)
    v_mfma_f32_32x32x16_bf16 v[128:143], a[144:147], a[120:123], v[128:143]
    ds_read_b64_tr_b16 a[132:133], v227 offset:0
    ds_read_b64_tr_b16 a[134:135], v231 offset:0
    s_waitcnt lgkmcnt(8)
    v_mfma_f32_32x32x16_bf16 v[144:159], a[148:151], a[120:123], v[144:159]
    ds_read_b64_tr_b16 a[136:137], v226 offset:16384
    ds_read_b64_tr_b16 a[138:139], v230 offset:16384
    s_waitcnt lgkmcnt(8)
    v_mfma_f32_32x32x16_bf16 v[128:143], a[152:155], a[124:127], v[128:143]
    ds_read_b64_tr_b16 a[140:141], v227 offset:16384
    ds_read_b64_tr_b16 a[142:143], v231 offset:16384
    s_waitcnt lgkmcnt(8)
    v_mfma_f32_32x32x16_bf16 v[144:159], a[156:159], a[124:127], v[144:159]
    ds_read_b64_tr_b16 a[144:145], v226 offset:32768
    ds_read_b64_tr_b16 a[146:147], v230 offset:32768
    s_waitcnt lgkmcnt(8)
    v_mfma_f32_32x32x16_bf16 v[160:175], a[128:131], a[96:99], 0
    ds_read_b64_tr_b16 a[148:149], v227 offset:32768
    ds_read_b64_tr_b16 a[150:151], v231 offset:32768
    s_waitcnt lgkmcnt(8)
    v_mfma_f32_32x32x16_bf16 v[176:191], a[132:135], a[96:99], 0
    ds_read_b64_tr_b16 a[152:153], v226 offset:49152
    ds_read_b64_tr_b16 a[154:155], v230 offset:49152
    s_waitcnt lgkmcnt(8)
    v_mfma_f32_32x32x16_bf16 v[160:175], a[136:139], a[100:103], v[160:175]
    ds_read_b64_tr_b16 a[156:157], v227 offset:49152
    ds_read_b64_tr_b16 a[158:159], v231 offset:49152
    s_waitcnt lgkmcnt(8)
    v_mfma_f32_32x32x16_bf16 v[176:191], a[140:143], a[100:103], v[176:191]
    v_cvt_pk_bf16_f32 v208, v128, v129
    v_cvt_pk_bf16_f32 v209, v130, v131
    v_cvt_pk_bf16_f32 v210, v132, v133
    v_cvt_pk_bf16_f32 v211, v134, v135
    v_xor_b32 v24, 0, v23
    ds_write_b128 v24, v[208:211]
    v_add_u32 v226, 0x10000, v226
    v_add_u32 v230, 0x10000, v230
    v_add_u32 v227, 0x10000, v227
    v_add_u32 v231, 0x10000, v231
    ds_read_b64_tr_b16 a[128:129], v226 offset:0
    ds_read_b64_tr_b16 a[130:131], v230 offset:0
    s_waitcnt lgkmcnt(9)
    v_mfma_f32_32x32x16_bf16 v[160:175], a[144:147], a[104:107], v[160:175]
    v_cvt_pk_bf16_f32 v212, v136, v137
    v_cvt_pk_bf16_f32 v213, v138, v139
    v_cvt_pk_bf16_f32 v214, v140, v141
    v_cvt_pk_bf16_f32 v215, v142, v143
    v_xor_b32 v24, 32, v23
    ds_write_b128 v24, v[212:215]
    ds_read_b64_tr_b16 a[132:133], v227 offset:0
    ds_read_b64_tr_b16 a[134:135], v231 offset:0
    s_waitcnt lgkmcnt(10)
    v_mfma_f32_32x32x16_bf16 v[176:191], a[148:151], a[104:107], v[176:191]
    v_cvt_pk_bf16_f32 v208, v144, v145
    v_cvt_pk_bf16_f32 v209, v146, v147
    v_cvt_pk_bf16_f32 v210, v148, v149
    v_cvt_pk_bf16_f32 v211, v150, v151
    v_xor_b32 v24, 64, v23
    ds_write_b128 v24, v[208:211]
    ds_read_b64_tr_b16 a[136:137], v226 offset:16384
    ds_read_b64_tr_b16 a[138:139], v230 offset:16384
    s_waitcnt lgkmcnt(11)
    v_mfma_f32_32x32x16_bf16 v[160:175], a[152:155], a[108:111], v[160:175]
    v_cvt_pk_bf16_f32 v212, v152, v153
    v_cvt_pk_bf16_f32 v213, v154, v155
    v_cvt_pk_bf16_f32 v214, v156, v157
    v_cvt_pk_bf16_f32 v215, v158, v159
    v_xor_b32 v24, 96, v23
    ds_write_b128 v24, v[212:215]
    ds_read_b64_tr_b16 a[140:141], v227 offset:16384
    ds_read_b64_tr_b16 a[142:143], v231 offset:16384
    s_waitcnt lgkmcnt(12)
    v_mfma_f32_32x32x16_bf16 v[176:191], a[156:159], a[108:111], v[176:191]
    ds_read_b64_tr_b16 a[144:145], v226 offset:32768
    ds_read_b64_tr_b16 a[146:147], v230 offset:32768
    s_waitcnt lgkmcnt(11)
    v_mfma_f32_32x32x16_bf16 v[160:175], a[128:131], a[112:115], v[160:175]
    s_waitcnt lgkmcnt(4)
    v_xor_b32 v24, 0, v20
    ds_read_b128 v[192:195], v24 offset:0
    v_xor_b32 v24, 128, v20
    ds_read_b128 v[196:199], v24 offset:2048
    v_xor_b32 v24, 0, v20
    ds_read_b128 v[200:203], v24 offset:4096
    v_xor_b32 v24, 128, v20
    ds_read_b128 v[204:207], v24 offset:6144
    ds_read_b64_tr_b16 a[148:149], v227 offset:32768
    ds_read_b64_tr_b16 a[150:151], v231 offset:32768
    v_mfma_f32_32x32x16_bf16 v[176:191], a[132:135], a[112:115], v[176:191]
    ds_read_b64_tr_b16 a[152:153], v226 offset:49152
    ds_read_b64_tr_b16 a[154:155], v230 offset:49152
    v_mfma_f32_32x32x16_bf16 v[160:175], a[136:139], a[116:119], v[160:175]
    ds_read_b64_tr_b16 a[156:157], v227 offset:49152
    ds_read_b64_tr_b16 a[158:159], v231 offset:49152
    s_waitcnt lgkmcnt(12)
    v_mfma_f32_32x32x16_bf16 v[176:191], a[140:143], a[116:119], v[176:191]
    s_waitcnt lgkmcnt(9)
    s_add_u32 s10, s9, 0
    buffer_store_dwordx4 v[192:195], v22, s[44:47], s10 offen sc1
    v_mfma_f32_32x32x16_bf16 v[160:175], a[144:147], a[120:123], v[160:175]
    s_waitcnt lgkmcnt(8)
    s_add_u32 s10, s9, 2097152
    buffer_store_dwordx4 v[196:199], v22, s[44:47], s10 offen sc1
    s_waitcnt lgkmcnt(4)
    v_mfma_f32_32x32x16_bf16 v[176:191], a[148:151], a[120:123], v[176:191]
    s_add_u32 s10, s9, 4194304
    buffer_store_dwordx4 v[200:203], v22, s[44:47], s10 offen sc1
    s_waitcnt lgkmcnt(2)
    v_mfma_f32_32x32x16_bf16 v[160:175], a[152:155], a[124:127], v[160:175]
    s_add_u32 s10, s9, 6291456
    buffer_store_dwordx4 v[204:207], v22, s[44:47], s10 offen sc1
    s_waitcnt lgkmcnt(0)
    v_mfma_f32_32x32x16_bf16 v[176:191], a[156:159], a[124:127], v[176:191]
    s_nop 7
    v_cvt_pk_bf16_f32 v208, v160, v161
    v_cvt_pk_bf16_f32 v209, v162, v163
    v_cvt_pk_bf16_f32 v210, v164, v165
    v_cvt_pk_bf16_f32 v211, v166, v167
    v_xor_b32 v24, 128, v23
    ds_write_b128 v24, v[208:211]
    v_cvt_pk_bf16_f32 v212, v168, v169
    v_cvt_pk_bf16_f32 v213, v170, v171
    v_cvt_pk_bf16_f32 v214, v172, v173
    v_cvt_pk_bf16_f32 v215, v174, v175
    v_xor_b32 v24, 160, v23
    ds_write_b128 v24, v[212:215]
    s_nop 3
    v_cvt_pk_bf16_f32 v208, v176, v177
    v_cvt_pk_bf16_f32 v209, v178, v179
    v_cvt_pk_bf16_f32 v210, v180, v181
    v_cvt_pk_bf16_f32 v211, v182, v183
    v_xor_b32 v24, 192, v23
    ds_write_b128 v24, v[208:211]
    v_cvt_pk_bf16_f32 v212, v184, v185
    v_cvt_pk_bf16_f32 v213, v186, v187
    v_cvt_pk_bf16_f32 v214, v188, v189
    v_cvt_pk_bf16_f32 v215, v190, v191
    v_xor_b32 v24, 224, v23
    ds_write_b128 v24, v[212:215]
    s_waitcnt lgkmcnt(0)
    v_xor_b32 v24, 128, v20
    ds_read_b128 v[192:195], v24 offset:0
    v_xor_b32 v24, 0, v20
    ds_read_b128 v[196:199], v24 offset:2048
    v_xor_b32 v24, 128, v20
    ds_read_b128 v[200:203], v24 offset:4096
    v_xor_b32 v24, 0, v20
    ds_read_b128 v[204:207], v24 offset:6144
    s_waitcnt lgkmcnt(3)
    s_add_u32 s10, s9, 128
    buffer_store_dwordx4 v[192:195], v22, s[44:47], s10 offen sc1
    s_waitcnt lgkmcnt(2)
    s_add_u32 s10, s9, 2097280
    buffer_store_dwordx4 v[196:199], v22, s[44:47], s10 offen sc1
    s_waitcnt lgkmcnt(1)
    s_add_u32 s10, s9, 4194432
    buffer_store_dwordx4 v[200:203], v22, s[44:47], s10 offen sc1
    s_waitcnt lgkmcnt(0)
    s_add_u32 s10, s9, 6291584
    buffer_store_dwordx4 v[204:207], v22, s[44:47], s10 offen sc1
    v_mov_b32 v128, v26
    v_mov_b32 v129, s42
    v_mov_b32 v130, v27
    v_mov_b32 v131, s42
    v_lshlrev_b32 v20, 14, v1
    s_lshl_b32 s8, s3, 4
    s_lshl_b32 s9, s4, 12
    s_add_u32 s8, s8, s9
    s_add_u32 s8, s8, 9437184
    v_cmp_gt_u32 vcc, 32, v1
    s_waitcnt vmcnt(0)
    s_and_saveexec_b64 s[14:15], vcc
    buffer_store_dwordx4 v[128:131], v20, s[44:47], s8 offen sc1
    s_mov_b64 exec, s[14:15]
    s_barrier
    s_cmp_lt_u32 s3, 128
    s_cbranch_scc1 L_LATE_E
    s_sub_u32 s5, s3, 128
    s_lshr_b32 s5, s5, 2
    s_and_b32 s6, s3, 3
    v_lshlrev_b32 v21, 4, v1
    s_lshl_b32 s8, s5, 2
    s_add_u32 s8, s8, s6
    s_lshl_b32 s7, s8, 12
    s_add_u32 s7, s7, 9437184
    s_lshl_b32 s8, s8, 16
    s_add_u32 s8, s8, 1048576
    s_lshl_b32 s9, s4, 14
    s_add_u32 s8, s8, s9
    v_lshlrev_b32 v20, 12, v3
    v_lshl_add_u32 v20, v2, 4, v20
    s_lshl_b32 s9, s4, 10
    s_add_u32 s9, s9, s7
    buffer_load_dwordx4 v[224:227], v21, s[44:47], s9 offen sc1
    buffer_load_dwordx4 v[228:231], v21, s[44:47], s9 offen sc1
    buffer_load_dwordx4 v[232:235], v21, s[44:47], s9 offen sc1
P_26:
    s_waitcnt vmcnt(2)
    v_sad_u32 v30, v225, s42, 0
    v_sad_u32 v30, v227, s42, v30
    v_cmp_ne_u32 vcc, 0, v30
    s_cbranch_vccz PK_28
    s_sub_u32 s59, s59, 1
    s_cbranch_scc1 L_END
    buffer_load_dwordx4 v[224:227], v21, s[44:47], s9 offen sc1
    s_waitcnt vmcnt(2)
    v_sad_u32 v30, v229, s42, 0
    v_sad_u32 v30, v231, s42, v30
    v_cmp_ne_u32 vcc, 0, v30
    s_cbranch_vccz PK_29
    buffer_load_dwordx4 v[228:231], v21, s[44:47], s9 offen sc1
    s_waitcnt vmcnt(2)
    v_sad_u32 v30, v233, s42, 0
    v_sad_u32 v30, v235, s42, v30
    v_cmp_ne_u32 vcc, 0, v30
    s_cbranch_vccz PK_30
    buffer_load_dwordx4 v[232:235], v21, s[44:47], s9 offen sc1
    s_branch P_26
PK_30:
    s_branch PD_27
PK_29:
    s_branch PD_27
PK_28:
PD_27:
    buffer_load_dwordx4 v[208:211], v21, s[44:47], s7 offen offset:0 sc1
    buffer_load_dwordx4 v[212:215], v21, s[44:47], s7 offen offset:1024 sc1
    buffer_load_dwordx4 v[216:219], v21, s[44:47], s7 offen offset:2048 sc1
    buffer_load_dwordx4 v[220:223], v21, s[44:47], s7 offen offset:3072 sc1
    buffer_load_dwordx4 v[64:67], v20, s[44:47], s8 offen offset:0 sc1
    buffer_load_dwordx4 v[68:71], v20, s[44:47], s8 offen offset:256 sc1
    buffer_load_dwordx4 v[72:75], v20, s[44:47], s8 offen offset:512 sc1
    buffer_load_dwordx4 v[76:79], v20, s[44:47], s8 offen offset:768 sc1
    buffer_load_dwordx4 v[80:83], v20, s[44:47], s8 offen offset:1024 sc1
    buffer_load_dwordx4 v[84:87], v20, s[44:47], s8 offen offset:1280 sc1
    buffer_load_dwordx4 v[88:91], v20, s[44:47], s8 offen offset:1536 sc1
    buffer_load_dwordx4 v[92:95], v20, s[44:47], s8 offen offset:1792 sc1
    buffer_load_dwordx4 v[96:99], v20, s[44:47], s8 offen offset:2048 sc1
    buffer_load_dwordx4 v[100:103], v20, s[44:47], s8 offen offset:2304 sc1
    buffer_load_dwordx4 v[104:107], v20, s[44:47], s8 offen offset:2560 sc1
    buffer_load_dwordx4 v[108:111], v20, s[44:47], s8 offen offset:2816 sc1
    buffer_load_dwordx4 v[112:115], v20, s[44:47], s8 offen offset:3072 sc1
    buffer_load_dwordx4 v[116:119], v20, s[44:47], s8 offen offset:3328 sc1
    buffer_load_dwordx4 v[120:123], v20, s[44:47], s8 offen offset:3584 sc1
    buffer_load_dwordx4 v[124:127], v20, s[44:47], s8 offen offset:3840 sc1
    s_waitcnt vmcnt(16)
    v_sad_u32 v30, v209, s42, 0
    v_sad_u32 v30, v211, s42, v30
    v_sad_u32 v30, v213, s42, v30
    v_sad_u32 v30, v215, s42, v30
    v_sad_u32 v30, v217, s42, v30
    v_sad_u32 v30, v219, s42, v30
    v_sad_u32 v30, v221, s42, v30
    v_sad_u32 v30, v223, s42, v30
    v_cmp_ne_u32 vcc, 0, v30
    s_cbranch_vccz L_S4P2
P_31:
    buffer_load_dwordx4 v[208:211], v21, s[44:47], s7 offen offset:0 sc1
    buffer_load_dwordx4 v[212:215], v21, s[44:47], s7 offen offset:1024 sc1
    buffer_load_dwordx4 v[216:219], v21, s[44:47], s7 offen offset:2048 sc1
    buffer_load_dwordx4 v[220:223], v21, s[44:47], s7 offen offset:3072 sc1
    s_waitcnt vmcnt(0)
    v_sad_u32 v30, v209, s42, 0
    v_sad_u32 v30, v211, s42, v30
    v_sad_u32 v30, v213, s42, v30
    v_sad_u32 v30, v215, s42, v30
    v_sad_u32 v30, v217, s42, v30
    v_sad_u32 v30, v219, s42, v30
    v_sad_u32 v30, v221, s42, v30
    v_sad_u32 v30, v223, s42, v30
    v_cmp_ne_u32 vcc, 0, v30
    s_cbranch_vccz PD_32
    s_sub_u32 s59, s59, 1
    s_cbranch_scc1 L_END
    s_branch P_31
PD_32:
L_S4P2:
    v_max3_f32 v22, v208, v212, v216
    v_max_f32 v22, v22, v220
    s_nop 1
    v_max_f32_dpp v22, v22, v22 row_shr:1 row_mask:0xf bank_mask:0xf
    s_nop 1
    v_max_f32_dpp v22, v22, v22 row_shr:2 row_mask:0xf bank_mask:0xf
    s_nop 1
    v_max_f32_dpp v22, v22, v22 row_shr:4 row_mask:0xf bank_mask:0xf
    s_nop 1
    v_max_f32_dpp v22, v22, v22 row_shr:8 row_mask:0xf bank_mask:0xf
    s_nop 1
    v_max_f32_dpp v22, v22, v22 row_bcast:15 row_mask:0xa bank_mask:0xf
    s_nop 1
    v_max_f32_dpp v22, v22, v22 row_bcast:31 row_mask:0xc bank_mask:0xf
    s_nop 0
    v_readlane_b32 s9, v22, 63
    s_nop 1
    v_subrev_f32 v208, s9, v208
    v_exp_f32 v208, v208
    v_subrev_f32 v212, s9, v212
    v_exp_f32 v212, v212
    v_subrev_f32 v216, s9, v216
    v_exp_f32 v216, v216
    v_subrev_f32 v220, s9, v220
    v_exp_f32 v220, v220
    s_nop 0
    v_mul_f32 v22, v208, v210
    v_fmac_f32 v22, v212, v214
    v_fmac_f32 v22, v216, v218
    v_fmac_f32 v22, v220, v222
    s_nop 1
    v_add_f32_dpp v22, v22, v22 row_shr:1 row_mask:0xf bank_mask:0xf bound_ctrl:0
    s_nop 1
    v_add_f32_dpp v22, v22, v22 row_shr:2 row_mask:0xf bank_mask:0xf bound_ctrl:0
    s_nop 1
    v_add_f32_dpp v22, v22, v22 row_shr:4 row_mask:0xf bank_mask:0xf bound_ctrl:0
    s_nop 1
    v_add_f32_dpp v22, v22, v22 row_shr:8 row_mask:0xf bank_mask:0xf bound_ctrl:0
    s_nop 1
    v_add_f32_dpp v22, v22, v22 row_bcast:15 row_mask:0xa bank_mask:0xf
    s_nop 1
    v_add_f32_dpp v22, v22, v22 row_bcast:31 row_mask:0xc bank_mask:0xf
    s_nop 0
    v_readlane_b32 s10, v22, 63
    v_mov_b32 v23, v208
    s_cmp_eq_u32 s4, 1
    s_cselect_b64 vcc, -1, 0
    v_cndmask_b32 v23, v23, v212, vcc
    s_cmp_eq_u32 s4, 2
    s_cselect_b64 vcc, -1, 0
    v_cndmask_b32 v23, v23, v216, vcc
    s_cmp_eq_u32 s4, 3
    s_cselect_b64 vcc, -1, 0
    v_cndmask_b32 v23, v23, v220, vcc
    v_cvt_pk_bf16_f32 v24, v23, v23
    v_and_b32 v25, 0xffff0000, v24
    v_sub_f32 v25, v23, v25
    v_cvt_pk_bf16_f32 v25, v25, v25
    v_lshlrev_b32 v26, 2, v0
    v_add_u32 v26, 131072, v26
    ds_write_b32 v26, v24
    ds_write_b32 v26, v25 offset:1024
    v_lshrrev_b32 v26, 3, v2
    v_lshlrev_b32 v26, 10, v26
    v_lshl_add_u32 v26, v3, 6, v26
    s_lshl_b32 s9, s4, 8
    s_add_u32 s9, s9, 131072
    v_add_u32 v26, s9, v26
    s_waitcnt lgkmcnt(0)
    ds_read_b128 v[192:195], v26 offset:0
    ds_read_b128 v[196:199], v26 offset:16
    ds_read_b128 v[200:203], v26 offset:32
    ds_read_b128 v[204:207], v26 offset:48
    s_waitcnt lgkmcnt(0)
    s_waitcnt vmcnt(0)
    v_and_b32 v8, v192, v4
    v_and_b32 v9, v192, v5
    v_and_b32 v10, v192, v6
    v_and_b32 v11, v192, v7
    v_and_b32 v12, v193, v4
    v_and_b32 v13, v193, v5
    v_and_b32 v14, v193, v6
    v_and_b32 v15, v193, v7
    v_mfma_f32_16x16x32_bf16 v[16:19], v[8:11], v[64:67], 0
    v_and_b32 v8, v194, v4
    v_and_b32 v9, v194, v5
    v_and_b32 v10, v194, v6
    v_and_b32 v11, v194, v7
    v_mfma_f32_16x16x32_bf16 v[16:19], v[12:15], v[68:71], v[16:19]
    v_and_b32 v12, v195, v4
    v_and_b32 v13, v195, v5
    v_and_b32 v14, v195, v6
    v_and_b32 v15, v195, v7
    v_mfma_f32_16x16x32_bf16 v[16:19], v[8:11], v[72:75], v[16:19]
    v_and_b32 v8, v196, v4
    v_and_b32 v9, v196, v5
    v_and_b32 v10, v196, v6
    v_and_b32 v11, v196, v7
    v_mfma_f32_16x16x32_bf16 v[16:19], v[12:15], v[76:79], v[16:19]
    v_and_b32 v12, v197, v4
    v_and_b32 v13, v197, v5
    v_and_b32 v14, v197, v6
    v_and_b32 v15, v197, v7
    v_mfma_f32_16x16x32_bf16 v[16:19], v[8:11], v[80:83], v[16:19]
    v_and_b32 v8, v198, v4
    v_and_b32 v9, v198, v5
    v_and_b32 v10, v198, v6
    v_and_b32 v11, v198, v7
    v_mfma_f32_16x16x32_bf16 v[16:19], v[12:15], v[84:87], v[16:19]
    v_and_b32 v12, v199, v4
    v_and_b32 v13, v199, v5
    v_and_b32 v14, v199, v6
    v_and_b32 v15, v199, v7
    v_mfma_f32_16x16x32_bf16 v[16:19], v[8:11], v[88:91], v[16:19]
    v_and_b32 v8, v200, v4
    v_and_b32 v9, v200, v5
    v_and_b32 v10, v200, v6
    v_and_b32 v11, v200, v7
    v_mfma_f32_16x16x32_bf16 v[16:19], v[12:15], v[92:95], v[16:19]
    v_and_b32 v12, v201, v4
    v_and_b32 v13, v201, v5
    v_and_b32 v14, v201, v6
    v_and_b32 v15, v201, v7
    v_mfma_f32_16x16x32_bf16 v[16:19], v[8:11], v[96:99], v[16:19]
    v_and_b32 v8, v202, v4
    v_and_b32 v9, v202, v5
    v_and_b32 v10, v202, v6
    v_and_b32 v11, v202, v7
    v_mfma_f32_16x16x32_bf16 v[16:19], v[12:15], v[100:103], v[16:19]
    v_and_b32 v12, v203, v4
    v_and_b32 v13, v203, v5
    v_and_b32 v14, v203, v6
    v_and_b32 v15, v203, v7
    v_mfma_f32_16x16x32_bf16 v[16:19], v[8:11], v[104:107], v[16:19]
    v_and_b32 v8, v204, v4
    v_and_b32 v9, v204, v5
    v_and_b32 v10, v204, v6
    v_and_b32 v11, v204, v7
    v_mfma_f32_16x16x32_bf16 v[16:19], v[12:15], v[108:111], v[16:19]
    v_and_b32 v12, v205, v4
    v_and_b32 v13, v205, v5
    v_and_b32 v14, v205, v6
    v_and_b32 v15, v205, v7
    v_mfma_f32_16x16x32_bf16 v[16:19], v[8:11], v[112:115], v[16:19]
    v_and_b32 v8, v206, v4
    v_and_b32 v9, v206, v5
    v_and_b32 v10, v206, v6
    v_and_b32 v11, v206, v7
    v_mfma_f32_16x16x32_bf16 v[16:19], v[12:15], v[116:119], v[16:19]
    v_and_b32 v12, v207, v4
    v_and_b32 v13, v207, v5
    v_and_b32 v14, v207, v6
    v_and_b32 v15, v207, v7
    v_mfma_f32_16x16x32_bf16 v[16:19], v[8:11], v[120:123], v[16:19]
    s_nop 1
    v_mfma_f32_16x16x32_bf16 v[16:19], v[12:15], v[124:127], v[16:19]
    s_nop 7
    v_lshrrev_b32 v20, 1, v3
    s_lshl_b32 s8, s4, 1
    v_add_u32 v20, s8, v20
    v_lshlrev_b32 v20, 9, v20
    v_and_b32 v22, 1, v3
    v_lshlrev_b32 v22, 4, v22
    v_lshl_add_u32 v22, v2, 5, v22
    s_mov_b32 s58, 135168
    v_add3_u32 v20, v20, v22, s58
    ds_write_b128 v20, v[16:19]
    s_waitcnt lgkmcnt(0)
    s_barrier
    v_cmp_gt_u32 vcc, 128, v0
    s_and_saveexec_b64 s[14:15], vcc
    s_cbranch_execz L_33
    v_lshlrev_b32 v20, 2, v0
    v_add_u32 v22, 135168, v20
    ds_read_b32 v192, v22 offset:0
    ds_read_b32 v193, v22 offset:512
    ds_read_b32 v194, v22 offset:1024
    ds_read_b32 v195, v22 offset:1536
    ds_read_b32 v196, v22 offset:2048
    ds_read_b32 v197, v22 offset:2560
    ds_read_b32 v198, v22 offset:3072
    ds_read_b32 v199, v22 offset:3584
    v_mov_b32 v23, s10
    v_rcp_f32 v23, v23
    s_waitcnt lgkmcnt(0)
    v_add_f32 v192, v192, v193
    v_add_f32 v192, v192, v194
    v_add_f32 v192, v192, v195
    v_add_f32 v192, v192, v196
    v_add_f32 v192, v192, v197
    v_add_f32 v192, v192, v198
    v_add_f32 v192, v192, v199
    v_mul_f32 v23, v23, v192
    v_cvt_pk_bf16_f32 v23, v23, v23
    v_add_u32 v20, 131072, v20
    ds_write_b32 v20, v23
L_33:
    s_mov_b64 exec, s[14:15]
    s_waitcnt lgkmcnt(0)
    s_barrier
    v_lshlrev_b32 v26, 5, v3
    s_lshl_b32 s9, s4, 7
    s_add_u32 s9, s9, 131072
    v_add_u32 v26, s9, v26
    ds_read_b128 v[192:195], v26 offset:0
    ds_read_b128 v[196:199], v26 offset:16
    s_waitcnt lgkmcnt(0)
    v_and_b32 v8, v192, v4
    v_and_b32 v9, v192, v5
    v_and_b32 v10, v192, v6
    v_and_b32 v11, v192, v7
    v_and_b32 v12, v193, v4
    v_and_b32 v13, v193, v5
    v_and_b32 v14, v193, v6
    v_and_b32 v15, v193, v7
    v_mfma_f32_16x16x32_bf16 v[16:19], v[8:11], v[32:35], 0
    v_and_b32 v8, v194, v4
    v_and_b32 v9, v194, v5
    v_and_b32 v10, v194, v6
    v_and_b32 v11, v194, v7
    v_mfma_f32_16x16x32_bf16 v[16:19], v[12:15], v[36:39], v[16:19]
    v_and_b32 v12, v195, v4
    v_and_b32 v13, v195, v5
    v_and_b32 v14, v195, v6
    v_and_b32 v15, v195, v7
    v_mfma_f32_16x16x32_bf16 v[16:19], v[8:11], v[40:43], v[16:19]
    v_and_b32 v8, v196, v4
    v_and_b32 v9, v196, v5
    v_and_b32 v10, v196, v6
    v_and_b32 v11, v196, v7
    v_mfma_f32_16x16x32_bf16 v[16:19], v[12:15], v[44:47], v[16:19]
    v_and_b32 v12, v197, v4
    v_and_b32 v13, v197, v5
    v_and_b32 v14, v197, v6
    v_and_b32 v15, v197, v7
    v_mfma_f32_16x16x32_bf16 v[16:19], v[8:11], v[48:51], v[16:19]
    v_and_b32 v8, v198, v4
    v_and_b32 v9, v198, v5
    v_and_b32 v10, v198, v6
    v_and_b32 v11, v198, v7
    v_mfma_f32_16x16x32_bf16 v[16:19], v[12:15], v[52:55], v[16:19]
    v_and_b32 v12, v199, v4
    v_and_b32 v13, v199, v5
    v_and_b32 v14, v199, v6
    v_and_b32 v15, v199, v7
    v_mfma_f32_16x16x32_bf16 v[16:19], v[8:11], v[56:59], v[16:19]
    s_nop 1
    v_mfma_f32_16x16x32_bf16 v[16:19], v[12:15], v[60:63], v[16:19]
    s_nop 7
    v_and_b32 v22, 1, v3
    v_lshlrev_b32 v22, 4, v22
    v_lshl_add_u32 v22, v2, 5, v22
    s_mul_i32 s8, s4, 512
    s_add_u32 s8, s8, 135168
    v_add_u32 v20, s8, v22
    v_cmp_gt_u32 vcc, 2, v3
    s_and_saveexec_b64 s[14:15], vcc
    ds_write_b128 v20, v[16:19]
    s_mov_b64 exec, s[14:15]
    s_waitcnt lgkmcnt(0)
    s_barrier
    s_lshl_b32 s9, s5, 2
    s_add_u32 s9, s9, s6
    s_lshl_b32 s9, s9, 9
    s_add_u32 s9, s9, 393216
    v_cmp_gt_u32 vcc, 64, v0
    s_and_saveexec_b64 s[14:15], vcc
    s_cbranch_execz L_34
    v_lshlrev_b32 v20, 3, v0
    v_add_u32 v22, 135168, v20
    ds_read_b64 v[192:193], v22 offset:0
    ds_read_b64 v[194:195], v22 offset:512
    ds_read_b64 v[196:197], v22 offset:1024
    ds_read_b64 v[198:199], v22 offset:1536
    s_waitcnt lgkmcnt(0)
    v_add_f32 v192, v192, v194
    v_add_f32 v193, v193, v195
    v_add_f32 v192, v192, v196
    v_add_f32 v193, v193, v197
    v_add_f32 v192, v192, v198
    v_add_f32 v193, v193, v199
    v_cvt_pk_bf16_f32 v22, v192, v193
    v_mov_b32 v23, s42
    buffer_store_dwordx2 v[22:23], v20, s[44:47], s9 offen sc1
L_34:
    s_mov_b64 exec, s[14:15]
    s_branch L_FIN
L_LATE_E:
    s_cmp_ge_u32 s3, 107
    s_cbranch_scc1 L_LW_DB
    s_cmp_ge_u32 s3, 67
    s_cbranch_scc1 L_LW_S0NB
    s_cmp_ge_u32 s3, 40
    s_cbranch_scc1 L_LW_MLPB
    s_mul_i32 s5, s3, 52
    s_lshr_b32 s5, s5, 8
    s_mul_i32 s6, s5, 5
    s_sub_u32 s6, s3, s6
    s_mov_b32 s48, s26
    s_mov_b32 s49, s27
    s_mov_b32 s50, 5242880
    s_mov_b32 s51, 0x20000
    s_lshl_b32 s8, s5, 9
    s_lshl_b32 s9, s4, 7
    s_add_u32 s8, s8, s9
    v_lshl_add_u32 v20, v3, 5, s8
    s_movk_i32 s10, 1280
    v_mul_lo_u32 v20, v20, s10
    s_lshl_b32 s9, s6, 8
    v_lshlrev_b32 v22, 4, v2
    v_add3_u32 v20, v20, v22, s9
    s_mov_b32 s12, 0
    buffer_load_dwordx4 a[0:3], v20, s[48:51], s12 offen nt
    s_mov_b32 s12, 1280
    buffer_load_dwordx4 a[4:7], v20, s[48:51], s12 offen nt
    s_mov_b32 s12, 2560
    buffer_load_dwordx4 a[8:11], v20, s[48:51], s12 offen nt
    s_mov_b32 s12, 3840
    buffer_load_dwordx4 a[12:15], v20, s[48:51], s12 offen nt
    s_mov_b32 s12, 5120
    buffer_load_dwordx4 a[16:19], v20, s[48:51], s12 offen nt
    s_mov_b32 s12, 6400
    buffer_load_dwordx4 a[20:23], v20, s[48:51], s12 offen nt
    s_mov_b32 s12, 7680
    buffer_load_dwordx4 a[24:27], v20, s[48:51], s12 offen nt
    s_mov_b32 s12, 8960
    buffer_load_dwordx4 a[28:31], v20, s[48:51], s12 offen nt
    s_mov_b32 s12, 10240
    buffer_load_dwordx4 a[32:35], v20, s[48:51], s12 offen nt
    s_mov_b32 s12, 11520
    buffer_load_dwordx4 a[36:39], v20, s[48:51], s12 offen nt
    s_mov_b32 s12, 12800
    buffer_load_dwordx4 a[40:43], v20, s[48:51], s12 offen nt
    s_mov_b32 s12, 14080
    buffer_load_dwordx4 a[44:47], v20, s[48:51], s12 offen nt
    s_mov_b32 s12, 15360
    buffer_load_dwordx4 a[48:51], v20, s[48:51], s12 offen nt
    s_mov_b32 s12, 16640
    buffer_load_dwordx4 a[52:55], v20, s[48:51], s12 offen nt
    s_mov_b32 s12, 17920
    buffer_load_dwordx4 a[56:59], v20, s[48:51], s12 offen nt
    s_mov_b32 s12, 19200
    buffer_load_dwordx4 a[60:63], v20, s[48:51], s12 offen nt
    s_mov_b32 s12, 20480
    buffer_load_dwordx4 a[64:67], v20, s[48:51], s12 offen nt
    s_mov_b32 s12, 21760
    buffer_load_dwordx4 a[68:71], v20, s[48:51], s12 offen nt
    s_mov_b32 s12, 23040
    buffer_load_dwordx4 a[72:75], v20, s[48:51], s12 offen nt
    s_mov_b32 s12, 24320
    buffer_load_dwordx4 a[76:79], v20, s[48:51], s12 offen nt
    s_mov_b32 s12, 25600
    buffer_load_dwordx4 a[80:83], v20, s[48:51], s12 offen nt
    s_mov_b32 s12, 26880
    buffer_load_dwordx4 a[84:87], v20, s[48:51], s12 offen nt
    s_mov_b32 s12, 28160
    buffer_load_dwordx4 a[88:91], v20, s[48:51], s12 offen nt
    s_mov_b32 s12, 29440
    buffer_load_dwordx4 a[92:95], v20, s[48:51], s12 offen nt
    s_mov_b32 s12, 30720
    buffer_load_dwordx4 a[160:163], v20, s[48:51], s12 offen nt
    s_mov_b32 s12, 32000
    buffer_load_dwordx4 a[164:167], v20, s[48:51], s12 offen nt
    s_mov_b32 s12, 33280
    buffer_load_dwordx4 a[168:171], v20, s[48:51], s12 offen nt
    s_mov_b32 s12, 34560
    buffer_load_dwordx4 a[172:175], v20, s[48:51], s12 offen nt
    s_mov_b32 s12, 35840
    buffer_load_dwordx4 a[176:179], v20, s[48:51], s12 offen nt
    s_mov_b32 s12, 37120
    buffer_load_dwordx4 a[180:183], v20, s[48:51], s12 offen nt
    s_mov_b32 s12, 38400
    buffer_load_dwordx4 a[184:187], v20, s[48:51], s12 offen nt
    s_mov_b32 s12, 39680
    buffer_load_dwordx4 a[188:191], v20, s[48:51], s12 offen nt
    s_branch L_LW_DB
L_LW_MLPB:
    s_sub_u32 s5, s3, 40
    s_mov_b32 s48, s30
    s_mov_b32 s49, s31
    s_mov_b32 s50, 2211840
    s_mov_b32 s51, 0x20000
    v_lshrrev_b32 v20, 3, v2
    v_lshl_add_u32 v20, v20, 2, v3
    v_mul_u32_u24 v20, 20, v20
    s_mul_i32 s8, s4, 160
    v_add_u32 v20, s8, v20
    s_movk_i32 s10, 3456
    v_mul_lo_u32 v20, v20, s10
    v_and_b32 v22, 7, v2
    v_lshlrev_b32 v22, 4, v22
    s_lshl_b32 s9, s5, 7
    v_add3_u32 v20, v20, v22, s9
    s_mov_b32 s12, 0
    buffer_load_dwordx4 a[0:3], v20, s[48:51], s12 offen nt
    s_mov_b32 s12, 3456
    buffer_load_dwordx4 a[4:7], v20, s[48:51], s12 offen nt
    s_mov_b32 s12, 6912
    buffer_load_dwordx4 a[8:11], v20, s[48:51], s12 offen nt
    s_mov_b32 s12, 10368
    buffer_load_dwordx4 a[12:15], v20, s[48:51], s12 offen nt
    s_mov_b32 s12, 13824
    buffer_load_dwordx4 a[16:19], v20, s[48:51], s12 offen nt
    s_mov_b32 s12, 17280
    buffer_load_dwordx4 a[20:23], v20, s[48:51], s12 offen nt
    s_mov_b32 s12, 20736
    buffer_load_dwordx4 a[24:27], v20, s[48:51], s12 offen nt
    s_mov_b32 s12, 24192
    buffer_load_dwordx4 a[28:31], v20, s[48:51], s12 offen nt
    s_mov_b32 s12, 27648
    buffer_load_dwordx4 a[32:35], v20, s[48:51], s12 offen nt
    s_mov_b32 s12, 31104
    buffer_load_dwordx4 a[36:39], v20, s[48:51], s12 offen nt
    s_mov_b32 s12, 34560
    buffer_load_dwordx4 a[40:43], v20, s[48:51], s12 offen nt
    s_mov_b32 s12, 38016
    buffer_load_dwordx4 a[44:47], v20, s[48:51], s12 offen nt
    s_mov_b32 s12, 41472
    buffer_load_dwordx4 a[48:51], v20, s[48:51], s12 offen nt
    s_mov_b32 s12, 44928
    buffer_load_dwordx4 a[52:55], v20, s[48:51], s12 offen nt
    s_mov_b32 s12, 48384
    buffer_load_dwordx4 a[56:59], v20, s[48:51], s12 offen nt
    s_mov_b32 s12, 51840
    buffer_load_dwordx4 a[60:63], v20, s[48:51], s12 offen nt
    s_mov_b32 s12, 55296
    buffer_load_dwordx4 a[64:67], v20, s[48:51], s12 offen nt
    s_mov_b32 s12, 58752
    buffer_load_dwordx4 a[68:71], v20, s[48:51], s12 offen nt
    s_mov_b32 s12, 62208
    buffer_load_dwordx4 a[72:75], v20, s[48:51], s12 offen nt
    s_mov_b32 s12, 65664
    buffer_load_dwordx4 a[76:79], v20, s[48:51], s12 offen nt
    s_mov_b32 s48, s32
    s_mov_b32 s49, s33
    s_mov_b32 s50, 2211840
    s_mov_b32 s51, 0x20000
    s_lshl_b32 s8, s5, 6
    s_lshl_b32 s9, s4, 4
    s_add_u32 s8, s8, s9
    v_lshl_add_u32 v20, v3, 2, s8
    s_movk_i32 s10, 1280
    v_mul_lo_u32 v20, v20, s10
    v_lshl_add_u32 v20, v2, 4, v20
    s_mov_b32 s12, 0
    buffer_load_dwordx4 a[80:83], v20, s[48:51], s12 offen nt
    s_mov_b32 s12, 256
    buffer_load_dwordx4 a[84:87], v20, s[48:51], s12 offen nt
    s_mov_b32 s12, 512
    buffer_load_dwordx4 a[88:91], v20, s[48:51], s12 offen nt
    s_mov_b32 s12, 768
    buffer_load_dwordx4 a[92:95], v20, s[48:51], s12 offen nt
    s_mov_b32 s12, 1024
    buffer_load_dwordx4 a[160:163], v20, s[48:51], s12 offen nt
    s_mov_b32 s12, 1280
    buffer_load_dwordx4 a[164:167], v20, s[48:51], s12 offen nt
    s_mov_b32 s12, 1536
    buffer_load_dwordx4 a[168:171], v20, s[48:51], s12 offen nt
    s_mov_b32 s12, 1792
    buffer_load_dwordx4 a[172:175], v20, s[48:51], s12 offen nt
    s_mov_b32 s12, 2048
    buffer_load_dwordx4 a[176:179], v20, s[48:51], s12 offen nt
    s_mov_b32 s12, 2304
    buffer_load_dwordx4 a[180:183], v20, s[48:51], s12 offen nt
    s_mov_b32 s12, 2560
    buffer_load_dwordx4 a[184:187], v20, s[48:51], s12 offen nt
    s_mov_b32 s12, 2816
    buffer_load_dwordx4 a[188:191], v20, s[48:51], s12 offen nt
    s_mov_b32 s12, 3072
    buffer_load_dwordx4 a[192:195], v20, s[48:51], s12 offen nt
    s_mov_b32 s12, 3328
    buffer_load_dwordx4 a[196:199], v20, s[48:51], s12 offen nt
    s_mov_b32 s12, 3584
    buffer_load_dwordx4 a[200:203], v20, s[48:51], s12 offen nt
    s_mov_b32 s12, 3840
    buffer_load_dwordx4 a[204:207], v20, s[48:51], s12 offen nt
    s_mov_b32 s12, 4096
    buffer_load_dwordx4 a[208:211], v20, s[48:51], s12 offen nt
    s_mov_b32 s12, 4352
    buffer_load_dwordx4 a[212:215], v20, s[48:51], s12 offen nt
    s_mov_b32 s12, 4608
    buffer_load_dwordx4 a[216:219], v20, s[48:51], s12 offen nt
    s_mov_b32 s12, 4864
    buffer_load_dwordx4 a[220:223], v20, s[48:51], s12 offen nt
    s_branch L_LW_DB
L_LW_S0NB:
    s_sub_u32 s6, s3, 47
    s_mov_b32 s48, s36
    s_mov_b32 s49, s37
    s_mov_b32 s50, 4915200
    s_mov_b32 s51, 0x20000
    v_lshrrev_b32 v20, 3, v2
    v_lshl_add_u32 v20, v20, 2, v3
    v_mul_u32_u24 v20, 20, v20
    s_mul_i32 s8, s4, 160
    v_add_u32 v20, s8, v20
    s_movk_i32 s10, 7680
    v_mul_lo_u32 v20, v20, s10
    v_and_b32 v22, 7, v2
    v_lshlrev_b32 v22, 4, v22
    s_lshl_b32 s11, s6, 7
    v_add3_u32 v20, v20, v22, s11
    s_mov_b32 s12, 0
    buffer_load_dwordx4 a[0:3], v20, s[48:51], s12 offen nt
    s_mov_b32 s12, 7680
    buffer_load_dwordx4 a[4:7], v20, s[48:51], s12 offen nt
    s_mov_b32 s12, 15360
    buffer_load_dwordx4 a[8:11], v20, s[48:51], s12 offen nt
    s_mov_b32 s12, 23040
    buffer_load_dwordx4 a[12:15], v20, s[48:51], s12 offen nt
    s_mov_b32 s12, 30720
    buffer_load_dwordx4 a[16:19], v20, s[48:51], s12 offen nt
    s_mov_b32 s12, 38400
    buffer_load_dwordx4 a[20:23], v20, s[48:51], s12 offen nt
    s_mov_b32 s12, 46080
    buffer_load_dwordx4 a[24:27], v20, s[48:51], s12 offen nt
    s_mov_b32 s12, 53760
    buffer_load_dwordx4 a[28:31], v20, s[48:51], s12 offen nt
    s_mov_b32 s12, 61440
    buffer_load_dwordx4 a[32:35], v20, s[48:51], s12 offen nt
    s_mov_b32 s12, 69120
    buffer_load_dwordx4 a[36:39], v20, s[48:51], s12 offen nt
    s_mov_b32 s12, 76800
    buffer_load_dwordx4 a[40:43], v20, s[48:51], s12 offen nt
    s_mov_b32 s12, 84480
    buffer_load_dwordx4 a[44:47], v20, s[48:51], s12 offen nt
    s_mov_b32 s12, 92160
    buffer_load_dwordx4 a[48:51], v20, s[48:51], s12 offen nt
    s_mov_b32 s12, 99840
    buffer_load_dwordx4 a[52:55], v20, s[48:51], s12 offen nt
    s_mov_b32 s12, 107520
    buffer_load_dwordx4 a[56:59], v20, s[48:51], s12 offen nt
    s_mov_b32 s12, 115200
    buffer_load_dwordx4 a[60:63], v20, s[48:51], s12 offen nt
    s_mov_b32 s12, 122880
    buffer_load_dwordx4 a[64:67], v20, s[48:51], s12 offen nt
    s_mov_b32 s12, 130560
    buffer_load_dwordx4 a[68:71], v20, s[48:51], s12 offen nt
    s_mov_b32 s12, 138240
    buffer_load_dwordx4 a[72:75], v20, s[48:51], s12 offen nt
    s_mov_b32 s12, 145920
    buffer_load_dwordx4 a[76:79], v20, s[48:51], s12 offen nt
L_LW_DB:
    s_cmp_ge_u32 s3, 107
    s_cbranch_scc1 L_FIN
    s_cmp_lt_u32 s3, 67
    s_cbranch_scc1 L_LATE_E2
    s_sub_u32 s6, s3, 47
    s_mov_b32 s52, s34
    s_mov_b32 s53, s35
    s_mov_b32 s54, 1280
    s_mov_b32 s55, 0x20000
    v_lshrrev_b32 v24, 3, v2
    v_lshl_add_u32 v24, v24, 2, v3
    v_mul_u32_u24 v24, 20, v24
    s_mul_i32 s8, s4, 160
    v_add_u32 v24, s8, v24
    v_lshlrev_b32 v21, 3, v0
    buffer_load_dwordx2 v[112:113], v21, s[52:55], 0 offen
    s_waitcnt vmcnt(0)
    v_lshlrev_b32 v114, 16, v112
    v_and_b32 v115, 0xffff0000, v112
    v_lshlrev_b32 v116, 16, v113
    v_and_b32 v117, 0xffff0000, v113
    v_mul_f32 v28, 0xbfb8aa3b, v114
    v_exp_f32 v28, v28
    s_nop 0
    v_add_f32 v28, 1.0, v28
    v_rcp_f32 v28, v28
    s_nop 0
    v_mul_f32 v114, v114, v28
    v_mul_f32 v28, 0xbfb8aa3b, v115
    v_exp_f32 v28, v28
    s_nop 0
    v_add_f32 v28, 1.0, v28
    v_rcp_f32 v28, v28
    s_nop 0
    v_mul_f32 v115, v115, v28
    v_mul_f32 v28, 0xbfb8aa3b, v116
    v_exp_f32 v28, v28
    s_nop 0
    v_add_f32 v28, 1.0, v28
    v_rcp_f32 v28, v28
    s_nop 0
    v_mul_f32 v116, v116, v28
    v_mul_f32 v28, 0xbfb8aa3b, v117
    v_exp_f32 v28, v28
    s_nop 0
    v_add_f32 v28, 1.0, v28
    v_rcp_f32 v28, v28
    s_nop 0
    v_mul_f32 v117, v117, v28
    v_cvt_pk_bf16_f32 v26, v114, v115
    v_cvt_pk_bf16_f32 v27, v116, v117
    v_perm_b32 v28, v26, v26, s56
    v_perm_b32 v29, v26, v26, s57
    v_perm_b32 v30, v27, v27, s56
    v_perm_b32 v31, v27, v27, s57
    v_lshlrev_b32 v21, 4, v0
    v_add_u32 v21, 131072, v21
    v_cmp_gt_u32 vcc, 160, v0
    s_and_saveexec_b64 s[14:15], vcc
    s_cbranch_execz L_35
    ds_write_b128 v21, v[28:31]
L_35:
    s_mov_b64 exec, s[14:15]
    s_waitcnt lgkmcnt(0)
    s_barrier
    v_lshlrev_b32 v21, 2, v24
    v_add_u32 v21, 131072, v21
    ds_read_b64 v[192:193], v21 offset:0
    ds_read_b64 v[194:195], v21 offset:8
    ds_read_b64 v[196:197], v21 offset:16
    ds_read_b64 v[198:199], v21 offset:24
    ds_read_b64 v[200:201], v21 offset:32
    ds_read_b64 v[202:203], v21 offset:40
    ds_read_b64 v[204:205], v21 offset:48
    ds_read_b64 v[206:207], v21 offset:56
    ds_read_b64 v[208:209], v21 offset:64
    ds_read_b64 v[210:211], v21 offset:72
    v_lshrrev_b32 v20, 3, v2
    v_lshrrev_b32 v21, 1, v3
    v_cmp_eq_u32 s[12:13], v20, v21
    s_lshl_b32 s8, s4, 1
    v_add_u32 v20, s8, v20
    v_lshlrev_b32 v20, 8, v20
    v_and_b32 v21, 7, v2
    v_lshlrev_b32 v21, 5, v21
    v_and_b32 v22, 1, v3
    v_lshlrev_b32 v22, 4, v22
    v_add3_u32 v20, v20, v21, v22
    v_add_u32 v20, 135168, v20
    s_waitcnt vmcnt(0) lgkmcnt(0)
    v_and_b32 v8, v192, v4
    v_and_b32 v9, v192, v5
    v_and_b32 v10, v192, v6
    v_and_b32 v11, v192, v7
    v_and_b32 v12, v193, v4
    v_and_b32 v13, v193, v5
    v_and_b32 v14, v193, v6
    v_and_b32 v15, v193, v7
    v_mfma_f32_16x16x32_bf16 v[16:19], v[8:11], a[0:3], 0
    v_and_b32 v8, v194, v4
    v_and_b32 v9, v194, v5
    v_and_b32 v10, v194, v6
    v_and_b32 v11, v194, v7
    v_mfma_f32_16x16x32_bf16 v[16:19], v[12:15], a[4:7], v[16:19]
    v_and_b32 v12, v195, v4
    v_and_b32 v13, v195, v5
    v_and_b32 v14, v195, v6
    v_and_b32 v15, v195, v7
    v_mfma_f32_16x16x32_bf16 v[16:19], v[8:11], a[8:11], v[16:19]
    v_and_b32 v8, v196, v4
    v_and_b32 v9, v196, v5
    v_and_b32 v10, v196, v6
    v_and_b32 v11, v196, v7
    v_mfma_f32_16x16x32_bf16 v[16:19], v[12:15], a[12:15], v[16:19]
    v_and_b32 v12, v197, v4
    v_and_b32 v13, v197, v5
    v_and_b32 v14, v197, v6
    v_and_b32 v15, v197, v7
    v_mfma_f32_16x16x32_bf16 v[16:19], v[8:11], a[16:19], v[16:19]
    v_and_b32 v8, v198, v4
    v_and_b32 v9, v198, v5
    v_and_b32 v10, v198, v6
    v_and_b32 v11, v198, v7
    v_mfma_f32_16x16x32_bf16 v[16:19], v[12:15], a[20:23], v[16:19]
    v_and_b32 v12, v199, v4
    v_and_b32 v13, v199, v5
    v_and_b32 v14, v199, v6
    v_and_b32 v15, v199, v7
    v_mfma_f32_16x16x32_bf16 v[16:19], v[8:11], a[24:27], v[16:19]
    v_and_b32 v8, v200, v4
    v_and_b32 v9, v200, v5
    v_and_b32 v10, v200, v6
    v_and_b32 v11, v200, v7
    v_mfma_f32_16x16x32_bf16 v[16:19], v[12:15], a[28:31], v[16:19]
    v_and_b32 v12, v201, v4
    v_and_b32 v13, v201, v5
    v_and_b32 v14, v201, v6
    v_and_b32 v15, v201, v7
    v_mfma_f32_16x16x32_bf16 v[16:19], v[8:11], a[32:35], v[16:19]
    v_and_b32 v8, v202, v4
    v_and_b32 v9, v202, v5
    v_and_b32 v10, v202, v6
    v_and_b32 v11, v202, v7
    v_mfma_f32_16x16x32_bf16 v[16:19], v[12:15], a[36:39], v[16:19]
    v_and_b32 v12, v203, v4
    v_and_b32 v13, v203, v5
    v_and_b32 v14, v203, v6
    v_and_b32 v15, v203, v7
    v_mfma_f32_16x16x32_bf16 v[16:19], v[8:11], a[40:43], v[16:19]
    v_and_b32 v8, v204, v4
    v_and_b32 v9, v204, v5
    v_and_b32 v10, v204, v6
    v_and_b32 v11, v204, v7
    v_mfma_f32_16x16x32_bf16 v[16:19], v[12:15], a[44:47], v[16:19]
    v_and_b32 v12, v205, v4
    v_and_b32 v13, v205, v5
    v_and_b32 v14, v205, v6
    v_and_b32 v15, v205, v7
    v_mfma_f32_16x16x32_bf16 v[16:19], v[8:11], a[48:51], v[16:19]
    v_and_b32 v8, v206, v4
    v_and_b32 v9, v206, v5
    v_and_b32 v10, v206, v6
    v_and_b32 v11, v206, v7
    v_mfma_f32_16x16x32_bf16 v[16:19], v[12:15], a[52:55], v[16:19]
    v_and_b32 v12, v207, v4
    v_and_b32 v13, v207, v5
    v_and_b32 v14, v207, v6
    v_and_b32 v15, v207, v7
    v_mfma_f32_16x16x32_bf16 v[16:19], v[8:11], a[56:59], v[16:19]
    v_and_b32 v8, v208, v4
    v_and_b32 v9, v208, v5
    v_and_b32 v10, v208, v6
    v_and_b32 v11, v208, v7
    v_mfma_f32_16x16x32_bf16 v[16:19], v[12:15], a[60:63], v[16:19]
    v_and_b32 v12, v209, v4
    v_and_b32 v13, v209, v5
    v_and_b32 v14, v209, v6
    v_and_b32 v15, v209, v7
    v_mfma_f32_16x16x32_bf16 v[16:19], v[8:11], a[64:67], v[16:19]
    v_and_b32 v8, v210, v4
    v_and_b32 v9, v210, v5
    v_and_b32 v10, v210, v6
    v_and_b32 v11, v210, v7
    v_mfma_f32_16x16x32_bf16 v[16:19], v[12:15], a[68:71], v[16:19]
    v_and_b32 v12, v211, v4
    v_and_b32 v13, v211, v5
    v_and_b32 v14, v211, v6
    v_and_b32 v15, v211, v7
    v_mfma_f32_16x16x32_bf16 v[16:19], v[8:11], a[72:75], v[16:19]
    s_nop 1
    v_mfma_f32_16x16x32_bf16 v[16:19], v[12:15], a[76:79], v[16:19]
    s_nop 7
    s_mov_b64 s[14:15], exec
    s_mov_b64 exec, s[12:13]
    ds_write_b128 v20, v[16:19]
    s_mov_b64 exec, s[14:15]
    s_waitcnt lgkmcnt(0)
    s_barrier
    v_cmp_gt_u32 vcc, 32, v0
    s_and_saveexec_b64 s[14:15], vcc
    s_cbranch_execz L_36
    v_lshlrev_b32 v20, 3, v0
    v_add_u32 v21, 135168, v20
    ds_read_b64 v[192:193], v21 offset:0
    ds_read_b64 v[194:195], v21 offset:256
    ds_read_b64 v[196:197], v21 offset:512
    ds_read_b64 v[198:199], v21 offset:768
    ds_read_b64 v[200:201], v21 offset:1024
    ds_read_b64 v[202:203], v21 offset:1280
    ds_read_b64 v[204:205], v21 offset:1536
    ds_read_b64 v[206:207], v21 offset:1792
    s_lshl_b32 s8, s6, 8
    s_add_u32 s8, s8, 4096
    v_mov_b32 v23, s42
    s_waitcnt lgkmcnt(0)
    v_pk_add_f32 v[192:193], v[192:193], v[200:201]
    v_pk_add_f32 v[194:195], v[194:195], v[202:203]
    v_pk_add_f32 v[196:197], v[196:197], v[204:205]
    v_pk_add_f32 v[198:199], v[198:199], v[206:207]
    v_pk_add_f32 v[192:193], v[192:193], v[196:197]
    v_pk_add_f32 v[194:195], v[194:195], v[198:199]
    v_pk_add_f32 v[192:193], v[192:193], v[194:195]
    v_cvt_pk_bf16_f32 v22, v192, v193
    buffer_store_dwordx2 v[22:23], v20, s[44:47], s8 offen sc1
L_36:
    s_mov_b64 exec, s[14:15]
    s_branch L_FIN
L_LATE_E2:
    s_cmp_ge_u32 s3, 40
    s_cbranch_scc1 L_MLP
    s_mul_i32 s5, s3, 52
    s_lshr_b32 s5, s5, 8
    s_mul_i32 s6, s5, 5
    s_sub_u32 s6, s3, s6
    s_lshl_b32 s8, s5, 2
    s_add_u32 s8, s8, s4
    s_lshl_b32 s8, s8, 11
    s_add_u32 s8, s8, 393216
    v_lshlrev_b32 v21, 3, v1
    s_lshl_b32 s9, s4, 9
    s_add_u32 s9, s9, 131072
    v_add_u32 v25, s9, v21
    v_lshlrev_b32 v26, 7, v3
    v_add_u32 v26, s9, v26
    v_and_b32 v22, 1, v3
    v_lshlrev_b32 v22, 4, v22
    v_lshl_add_u32 v22, v2, 5, v22
    s_lshl_b32 s9, s4, 9
    s_add_u32 s9, s9, 135168
    v_add_u32 v24, s9, v22
    v_cmp_gt_u32 s[12:13], 2, v3
    s_lshl_b32 s10, s5, 12
    s_lshl_b32 s11, s6, 9
    s_add_u32 s10, s10, s11
    s_add_u32 s10, s10, 458752
    v_lshlrev_b32 v27, 3, v0
    v_add_u32 v23, 135168, v27
    buffer_load_dwordx2 v[224:225], v21, s[44:47], s8 offen offset:0 sc1
    buffer_load_dwordx2 v[226:227], v21, s[44:47], s8 offen offset:512 sc1
    buffer_load_dwordx2 v[228:229], v21, s[44:47], s8 offen offset:1024 sc1
    buffer_load_dwordx2 v[230:231], v21, s[44:47], s8 offen offset:1536 sc1
    buffer_load_dwordx2 v[232:233], v21, s[44:47], s8 offen offset:0 sc1
    buffer_load_dwordx2 v[234:235], v21, s[44:47], s8 offen offset:512 sc1
    buffer_load_dwordx2 v[236:237], v21, s[44:47], s8 offen offset:1024 sc1
    buffer_load_dwordx2 v[238:239], v21, s[44:47], s8 offen offset:1536 sc1
    buffer_load_dwordx2 v[240:241], v21, s[44:47], s8 offen offset:0 sc1
    buffer_load_dwordx2 v[242:243], v21, s[44:47], s8 offen offset:512 sc1
    buffer_load_dwordx2 v[244:245], v21, s[44:47], s8 offen offset:1024 sc1
    buffer_load_dwordx2 v[246:247], v21, s[44:47], s8 offen offset:1536 sc1
P_37:
    s_waitcnt vmcnt(8)
    v_sad_u32 v30, v225, s42, 0
    v_sad_u32 v30, v227, s42, v30
    v_sad_u32 v30, v229, s42, v30
    v_sad_u32 v30, v231, s42, v30
    v_cmp_ne_u32 vcc, 0, v30
    s_cbranch_vccz PK_39
    s_sub_u32 s59, s59, 1
    s_cbranch_scc1 L_END
    s_sleep 3
    buffer_load_dwordx2 v[224:225], v21, s[44:47], s8 offen offset:0 sc1
    buffer_load_dwordx2 v[226:227], v21, s[44:47], s8 offen offset:512 sc1
    buffer_load_dwordx2 v[228:229], v21, s[44:47], s8 offen offset:1024 sc1
    buffer_load_dwordx2 v[230:231], v21, s[44:47], s8 offen offset:1536 sc1
    s_waitcnt vmcnt(8)
    v_sad_u32 v30, v233, s42, 0
    v_sad_u32 v30, v235, s42, v30
    v_sad_u32 v30, v237, s42, v30
    v_sad_u32 v30, v239, s42, v30
    v_cmp_ne_u32 vcc, 0, v30
    s_cbranch_vccz PK_40
    s_sleep 3
    buffer_load_dwordx2 v[232:233], v21, s[44:47], s8 offen offset:0 sc1
    buffer_load_dwordx2 v[234:235], v21, s[44:47], s8 offen offset:512 sc1
    buffer_load_dwordx2 v[236:237], v21, s[44:47], s8 offen offset:1024 sc1
    buffer_load_dwordx2 v[238:239], v21, s[44:47], s8 offen offset:1536 sc1
    s_waitcnt vmcnt(8)
    v_sad_u32 v30, v241, s42, 0
    v_sad_u32 v30, v243, s42, v30
    v_sad_u32 v30, v245, s42, v30
    v_sad_u32 v30, v247, s42, v30
    v_cmp_ne_u32 vcc, 0, v30
    s_cbranch_vccz PK_41
    s_sleep 3
    buffer_load_dwordx2 v[240:241], v21, s[44:47], s8 offen offset:0 sc1
    buffer_load_dwordx2 v[242:243], v21, s[44:47], s8 offen offset:512 sc1
    buffer_load_dwordx2 v[244:245], v21, s[44:47], s8 offen offset:1024 sc1
    buffer_load_dwordx2 v[246:247], v21, s[44:47], s8 offen offset:1536 sc1
    s_branch P_37
PK_41:
    v_mov_b32 v248, v240
    v_mov_b32 v249, v242
    v_mov_b32 v250, v244
    v_mov_b32 v251, v246
    s_branch PD_38
PK_40:
    v_mov_b32 v248, v232
    v_mov_b32 v249, v234
    v_mov_b32 v250, v236
    v_mov_b32 v251, v238
    s_branch PD_38
PK_39:
    v_mov_b32 v248, v224
    v_mov_b32 v249, v226
    v_mov_b32 v250, v228
    v_mov_b32 v251, v230
PD_38:
    v_lshlrev_b32 v8, 16, v248
    v_and_b32 v9, 0xffff0000, v248
    v_lshlrev_b32 v10, 16, v249
    v_and_b32 v11, 0xffff0000, v249
    v_lshlrev_b32 v12, 16, v250
    v_and_b32 v13, 0xffff0000, v250
    v_lshlrev_b32 v14, 16, v251
    v_and_b32 v15, 0xffff0000, v251
    v_pk_add_f32 v[8:9], v[8:9], v[10:11]
    v_pk_add_f32 v[12:13], v[12:13], v[14:15]
    v_pk_add_f32 v[8:9], v[8:9], v[12:13]
    v_cvt_pk_bf16_f32 v28, v8, v9
    v_perm_b32 v30, v28, v28, s56
    v_perm_b32 v31, v28, v28, s57
    ds_write_b64 v25, v[30:31]
    s_waitcnt lgkmcnt(0)
    ds_read_b128 v[192:195], v26 offset:0
    ds_read_b128 v[196:199], v26 offset:16
    ds_read_b128 v[200:203], v26 offset:32
    ds_read_b128 v[204:207], v26 offset:48
    ds_read_b128 v[208:211], v26 offset:64
    ds_read_b128 v[212:215], v26 offset:80
    ds_read_b128 v[216:219], v26 offset:96
    ds_read_b128 v[220:223], v26 offset:112
    s_waitcnt lgkmcnt(6)
    v_and_b32 v8, v192, v4
    v_and_b32 v9, v192, v5
    v_and_b32 v10, v192, v6
    v_and_b32 v11, v192, v7
    v_and_b32 v12, v193, v4
    v_and_b32 v13, v193, v5
    v_and_b32 v14, v193, v6
    v_and_b32 v15, v193, v7
    v_mfma_f32_16x16x32_bf16 v[16:19], v[8:11], a[0:3], 0
    v_and_b32 v8, v194, v4
    v_and_b32 v9, v194, v5
    v_and_b32 v10, v194, v6
    v_and_b32 v11, v194, v7
    v_mfma_f32_16x16x32_bf16 v[16:19], v[12:15], a[4:7], v[16:19]
    v_and_b32 v12, v195, v4
    v_and_b32 v13, v195, v5
    v_and_b32 v14, v195, v6
    v_and_b32 v15, v195, v7
    s_waitcnt lgkmcnt(5)
    v_mfma_f32_16x16x32_bf16 v[16:19], v[8:11], a[8:11], v[16:19]
    v_and_b32 v8, v196, v4
    v_and_b32 v9, v196, v5
    v_and_b32 v10, v196, v6
    v_and_b32 v11, v196, v7
    v_mfma_f32_16x16x32_bf16 v[16:19], v[12:15], a[12:15], v[16:19]
    v_and_b32 v12, v197, v4
    v_and_b32 v13, v197, v5
    v_and_b32 v14, v197, v6
    v_and_b32 v15, v197, v7
    v_mfma_f32_16x16x32_bf16 v[16:19], v[8:11], a[16:19], v[16:19]
    v_and_b32 v8, v198, v4
    v_and_b32 v9, v198, v5
    v_and_b32 v10, v198, v6
    v_and_b32 v11, v198, v7
    v_mfma_f32_16x16x32_bf16 v[16:19], v[12:15], a[20:23], v[16:19]
    v_and_b32 v12, v199, v4
    v_and_b32 v13, v199, v5
    v_and_b32 v14, v199, v6
    v_and_b32 v15, v199, v7
    s_waitcnt lgkmcnt(4)
    v_mfma_f32_16x16x32_bf16 v[16:19], v[8:11], a[24:27], v[16:19]
    v_and_b32 v8, v200, v4
    v_and_b32 v9, v200, v5
    v_and_b32 v10, v200, v6
    v_and_b32 v11, v200, v7
    v_mfma_f32_16x16x32_bf16 v[16:19], v[12:15], a[28:31], v[16:19]
    v_and_b32 v12, v201, v4
    v_and_b32 v13, v201, v5
    v_and_b32 v14, v201, v6
    v_and_b32 v15, v201, v7
    v_mfma_f32_16x16x32_bf16 v[16:19], v[8:11], a[32:35], v[16:19]
    v_and_b32 v8, v202, v4
    v_and_b32 v9, v202, v5
    v_and_b32 v10, v202, v6
    v_and_b32 v11, v202, v7
    v_mfma_f32_16x16x32_bf16 v[16:19], v[12:15], a[36:39], v[16:19]
    v_and_b32 v12, v203, v4
    v_and_b32 v13, v203, v5
    v_and_b32 v14, v203, v6
    v_and_b32 v15, v203, v7
    s_waitcnt lgkmcnt(3)
    v_mfma_f32_16x16x32_bf16 v[16:19], v[8:11], a[40:43], v[16:19]
    v_and_b32 v8, v204, v4
    v_and_b32 v9, v204, v5
    v_and_b32 v10, v204, v6
    v_and_b32 v11, v204, v7
    v_mfma_f32_16x16x32_bf16 v[16:19], v[12:15], a[44:47], v[16:19]
    v_and_b32 v12, v205, v4
    v_and_b32 v13, v205, v5
    v_and_b32 v14, v205, v6
    v_and_b32 v15, v205, v7
    v_mfma_f32_16x16x32_bf16 v[16:19], v[8:11], a[48:51], v[16:19]
    v_and_b32 v8, v206, v4
    v_and_b32 v9, v206, v5
    v_and_b32 v10, v206, v6
    v_and_b32 v11, v206, v7
    v_mfma_f32_16x16x32_bf16 v[16:19], v[12:15], a[52:55], v[16:19]
    v_and_b32 v12, v207, v4
    v_and_b32 v13, v207, v5
    v_and_b32 v14, v207, v6
    v_and_b32 v15, v207, v7
    s_waitcnt lgkmcnt(2)
    v_mfma_f32_16x16x32_bf16 v[16:19], v[8:11], a[56:59], v[16:19]
    v_and_b32 v8, v208, v4
    v_and_b32 v9, v208, v5
    v_and_b32 v10, v208, v6
    v_and_b32 v11, v208, v7
    v_mfma_f32_16x16x32_bf16 v[16:19], v[12:15], a[60:63], v[16:19]
    v_and_b32 v12, v209, v4
    v_and_b32 v13, v209, v5
    v_and_b32 v14, v209, v6
    v_and_b32 v15, v209, v7
    v_mfma_f32_16x16x32_bf16 v[16:19], v[8:11], a[64:67], v[16:19]
    v_and_b32 v8, v210, v4
    v_and_b32 v9, v210, v5
    v_and_b32 v10, v210, v6
    v_and_b32 v11, v210, v7
    v_mfma_f32_16x16x32_bf16 v[16:19], v[12:15], a[68:71], v[16:19]
    v_and_b32 v12, v211, v4
    v_and_b32 v13, v211, v5
    v_and_b32 v14, v211, v6
    v_and_b32 v15, v211, v7
    s_waitcnt lgkmcnt(1)
    v_mfma_f32_16x16x32_bf16 v[16:19], v[8:11], a[72:75], v[16:19]
    v_and_b32 v8, v212, v4
    v_and_b32 v9, v212, v5
    v_and_b32 v10, v212, v6
    v_and_b32 v11, v212, v7
    v_mfma_f32_16x16x32_bf16 v[16:19], v[12:15], a[76:79], v[16:19]
    v_and_b32 v12, v213, v4
    v_and_b32 v13, v213, v5
    v_and_b32 v14, v213, v6
    v_and_b32 v15, v213, v7
    v_mfma_f32_16x16x32_bf16 v[16:19], v[8:11], a[80:83], v[16:19]
    v_and_b32 v8, v214, v4
    v_and_b32 v9, v214, v5
    v_and_b32 v10, v214, v6
    v_and_b32 v11, v214, v7
    v_mfma_f32_16x16x32_bf16 v[16:19], v[12:15], a[84:87], v[16:19]
    v_and_b32 v12, v215, v4
    v_and_b32 v13, v215, v5
    v_and_b32 v14, v215, v6
    v_and_b32 v15, v215, v7
    s_waitcnt lgkmcnt(0)
    v_mfma_f32_16x16x32_bf16 v[16:19], v[8:11], a[88:91], v[16:19]
    v_and_b32 v8, v216, v4
    v_and_b32 v9, v216, v5
    v_and_b32 v10, v216, v6
    v_and_b32 v11, v216, v7
    v_mfma_f32_16x16x32_bf16 v[16:19], v[12:15], a[92:95], v[16:19]
    v_and_b32 v12, v217, v4
    v_and_b32 v13, v217, v5
    v_and_b32 v14, v217, v6
    v_and_b32 v15, v217, v7
    v_mfma_f32_16x16x32_bf16 v[16:19], v[8:11], a[160:163], v[16:19]
    v_and_b32 v8, v218, v4
    v_and_b32 v9, v218, v5
    v_and_b32 v10, v218, v6
    v_and_b32 v11, v218, v7
    v_mfma_f32_16x16x32_bf16 v[16:19], v[12:15], a[164:167], v[16:19]
    v_and_b32 v12, v219, v4
    v_and_b32 v13, v219, v5
    v_and_b32 v14, v219, v6
    v_and_b32 v15, v219, v7
    s_waitcnt lgkmcnt(0)
    v_mfma_f32_16x16x32_bf16 v[16:19], v[8:11], a[168:171], v[16:19]
    v_and_b32 v8, v220, v4
    v_and_b32 v9, v220, v5
    v_and_b32 v10, v220, v6
    v_and_b32 v11, v220, v7
    v_mfma_f32_16x16x32_bf16 v[16:19], v[12:15], a[172:175], v[16:19]
    v_and_b32 v12, v221, v4
    v_and_b32 v13, v221, v5
    v_and_b32 v14, v221, v6
    v_and_b32 v15, v221, v7
    v_mfma_f32_16x16x32_bf16 v[16:19], v[8:11], a[176:179], v[16:19]
    v_and_b32 v8, v222, v4
    v_and_b32 v9, v222, v5
    v_and_b32 v10, v222, v6
    v_and_b32 v11, v222, v7
    v_mfma_f32_16x16x32_bf16 v[16:19], v[12:15], a[180:183], v[16:19]
    v_and_b32 v12, v223, v4
    v_and_b32 v13, v223, v5
    v_and_b32 v14, v223, v6
    v_and_b32 v15, v223, v7
    v_mfma_f32_16x16x32_bf16 v[16:19], v[8:11], a[184:187], v[16:19]
    s_nop 1
    v_mfma_f32_16x16x32_bf16 v[16:19], v[12:15], a[188:191], v[16:19]
    s_nop 7
    s_mov_b64 s[14:15], exec
    s_mov_b64 exec, s[12:13]
    ds_write_b128 v24, v[16:19]
    s_mov_b64 exec, s[14:15]
    s_waitcnt lgkmcnt(0)
    s_barrier
    v_cmp_gt_u32 vcc, 64, v0
    s_and_saveexec_b64 s[14:15], vcc
    s_cbranch_execz L_42
    ds_read_b64 v[192:193], v23 offset:0
    ds_read_b64 v[194:195], v23 offset:512
    ds_read_b64 v[196:197], v23 offset:1024
    ds_read_b64 v[198:199], v23 offset:1536
    v_mov_b32 v29, s42
    s_waitcnt lgkmcnt(0)
    v_pk_add_f32 v[192:193], v[192:193], v[194:195]
    v_pk_add_f32 v[196:197], v[196:197], v[198:199]
    v_pk_add_f32 v[192:193], v[192:193], v[196:197]
    v_cvt_pk_bf16_f32 v28, v192, v193
    buffer_store_dwordx2 v[28:29], v27, s[44:47], s10 offen sc1
L_42:
    s_mov_b64 exec, s[14:15]
    s_branch L_FIN
L_MLP:
    s_sub_u32 s5, s3, 40
    s_mov_b32 s52, s16
    s_mov_b32 s53, s17
    s_mov_b32 s54, 1280
    s_mov_b32 s55, 0x20000
    v_cmp_gt_u32 vcc, 160, v0
    s_and_saveexec_b64 s[14:15], vcc
    s_cbranch_execz L_43
    v_lshlrev_b32 v21, 3, v0
    buffer_load_dwordx2 v[224:225], v21, s[52:55], 0 offen
    v_lshlrev_b32 v21, 4, v0
P_44:
    s_mov_b32 s12, 9216
    buffer_load_dwordx4 v[192:195], v21, s[44:47], s12 offen sc1
    s_mov_b32 s12, 11776
    buffer_load_dwordx4 v[196:199], v21, s[44:47], s12 offen sc1
    s_mov_b32 s12, 14336
    buffer_load_dwordx4 v[200:203], v21, s[44:47], s12 offen sc1
    s_mov_b32 s12, 16896
    buffer_load_dwordx4 v[204:207], v21, s[44:47], s12 offen sc1
    s_waitcnt vmcnt(0)
    v_sad_u32 v30, v193, s42, 0
    v_sad_u32 v30, v195, s42, v30
    v_sad_u32 v30, v197, s42, v30
    v_sad_u32 v30, v199, s42, v30
    v_sad_u32 v30, v201, s42, v30
    v_sad_u32 v30, v203, s42, v30
    v_sad_u32 v30, v205, s42, v30
    v_sad_u32 v30, v207, s42, v30
    v_cmp_ne_u32 vcc, 0, v30
    s_cbranch_vccz PD_45
    s_sub_u32 s59, s59, 1
    s_cbranch_scc1 L_END
    s_sleep 4
    s_branch P_44
PD_45:
    v_lshlrev_b32 v240, 16, v192
    v_and_b32 v241, 0xffff0000, v192
    v_lshlrev_b32 v242, 16, v194
    v_and_b32 v243, 0xffff0000, v194
    v_lshlrev_b32 v244, 16, v196
    v_and_b32 v245, 0xffff0000, v196
    v_lshlrev_b32 v246, 16, v198
    v_and_b32 v247, 0xffff0000, v198
    v_lshlrev_b32 v248, 16, v200
    v_and_b32 v249, 0xffff0000, v200
    v_lshlrev_b32 v250, 16, v202
    v_and_b32 v251, 0xffff0000, v202
    v_lshlrev_b32 v252, 16, v204
    v_and_b32 v253, 0xffff0000, v204
    v_lshlrev_b32 v254, 16, v206
    v_and_b32 v255, 0xffff0000, v206
    v_lshlrev_b32 v236, 16, v224
    v_and_b32 v237, 0xffff0000, v224
    v_lshlrev_b32 v238, 16, v225
    v_and_b32 v239, 0xffff0000, v225
    v_add_f32 v248, 1.0, v248
    v_add_f32 v249, 1.0, v249
    v_add_f32 v250, 1.0, v250
    v_add_f32 v251, 1.0, v251
L_43:
    s_mov_b64 exec, s[14:15]
    v_cmp_gt_u32 vcc, 160, v0
    s_and_saveexec_b64 s[14:15], vcc
    s_cbranch_execz L_46
    v_lshlrev_b32 v21, 4, v0
    v_add_u32 v25, 147456, v21
    ds_write_b128 v25, v[252:255] offset:4096
    s_mov_b32 s12, 458752
    buffer_load_dwordx4 v[192:195], v21, s[44:47], s12 offen sc1
    s_mov_b32 s12, 462848
    buffer_load_dwordx4 v[196:199], v21, s[44:47], s12 offen sc1
    s_mov_b32 s12, 466944
    buffer_load_dwordx4 v[200:203], v21, s[44:47], s12 offen sc1
    s_mov_b32 s12, 471040
    buffer_load_dwordx4 v[204:207], v21, s[44:47], s12 offen sc1
    s_mov_b32 s12, 475136
    buffer_load_dwordx4 v[208:211], v21, s[44:47], s12 offen sc1
    s_mov_b32 s12, 479232
    buffer_load_dwordx4 v[212:215], v21, s[44:47], s12 offen sc1
    s_mov_b32 s12, 483328
    buffer_load_dwordx4 v[216:219], v21, s[44:47], s12 offen sc1
    s_mov_b32 s12, 487424
    buffer_load_dwordx4 v[220:223], v21, s[44:47], s12 offen sc1
L_X1:
    s_waitcnt vmcnt(4)
    v_sad_u32 v30, v193, s42, 0
    v_sad_u32 v30, v195, s42, v30
    v_sad_u32 v30, v197, s42, v30
    v_sad_u32 v30, v199, s42, v30
    v_sad_u32 v30, v201, s42, v30
    v_sad_u32 v30, v203, s42, v30
    v_sad_u32 v30, v205, s42, v30
    v_sad_u32 v30, v207, s42, v30
    v_cmp_ne_u32 vcc, 0, v30
    s_cbranch_vccz L_X1B
    s_sub_u32 s59, s59, 1
    s_cbranch_scc1 L_END
    s_sleep 4
    s_mov_b32 s12, 458752
    buffer_load_dwordx4 v[192:195], v21, s[44:47], s12 offen sc1
    s_mov_b32 s12, 462848
    buffer_load_dwordx4 v[196:199], v21, s[44:47], s12 offen sc1
    s_mov_b32 s12, 466944
    buffer_load_dwordx4 v[200:203], v21, s[44:47], s12 offen sc1
    s_mov_b32 s12, 471040
    buffer_load_dwordx4 v[204:207], v21, s[44:47], s12 offen sc1
    s_waitcnt vmcnt(4)
    v_sad_u32 v30, v209, s42, 0
    v_sad_u32 v30, v211, s42, v30
    v_sad_u32 v30, v213, s42, v30
    v_sad_u32 v30, v215, s42, v30
    v_sad_u32 v30, v217, s42, v30
    v_sad_u32 v30, v219, s42, v30
    v_sad_u32 v30, v221, s42, v30
    v_sad_u32 v30, v223, s42, v30
    v_cmp_ne_u32 vcc, 0, v30
    s_cbranch_vccz L_X1A
    s_sleep 4
    s_mov_b32 s12, 475136
    buffer_load_dwordx4 v[208:211], v21, s[44:47], s12 offen sc1
    s_mov_b32 s12, 479232
    buffer_load_dwordx4 v[212:215], v21, s[44:47], s12 offen sc1
    s_mov_b32 s12, 483328
    buffer_load_dwordx4 v[216:219], v21, s[44:47], s12 offen sc1
    s_mov_b32 s12, 487424
    buffer_load_dwordx4 v[220:223], v21, s[44:47], s12 offen sc1
    s_branch L_X1
L_X1A:
    s_waitcnt vmcnt(0)
    v_sad_u32 v30, v193, s42, 0
    v_sad_u32 v30, v195, s42, v30
    v_sad_u32 v30, v197, s42, v30
    v_sad_u32 v30, v199, s42, v30
    v_sad_u32 v30, v201, s42, v30
    v_sad_u32 v30, v203, s42, v30
    v_sad_u32 v30, v205, s42, v30
    v_sad_u32 v30, v207, s42, v30
    v_cmp_ne_u32 vcc, 0, v30
    s_cbranch_vccz L_X1D
    s_sub_u32 s59, s59, 1
    s_cbranch_scc1 L_END
    s_mov_b32 s12, 458752
    buffer_load_dwordx4 v[192:195], v21, s[44:47], s12 offen sc1
    s_mov_b32 s12, 462848
    buffer_load_dwordx4 v[196:199], v21, s[44:47], s12 offen sc1
    s_mov_b32 s12, 466944
    buffer_load_dwordx4 v[200:203], v21, s[44:47], s12 offen sc1
    s_mov_b32 s12, 471040
    buffer_load_dwordx4 v[204:207], v21, s[44:47], s12 offen sc1
    s_branch L_X1A
L_X1B:
    s_waitcnt vmcnt(0)
    v_sad_u32 v30, v209, s42, 0
    v_sad_u32 v30, v211, s42, v30
    v_sad_u32 v30, v213, s42, v30
    v_sad_u32 v30, v215, s42, v30
    v_sad_u32 v30, v217, s42, v30
    v_sad_u32 v30, v219, s42, v30
    v_sad_u32 v30, v221, s42, v30
    v_sad_u32 v30, v223, s42, v30
    v_cmp_ne_u32 vcc, 0, v30
    s_cbranch_vccz L_X1D
    s_sub_u32 s59, s59, 1
    s_cbranch_scc1 L_END
    s_mov_b32 s12, 475136
    buffer_load_dwordx4 v[208:211], v21, s[44:47], s12 offen sc1
    s_mov_b32 s12, 479232
    buffer_load_dwordx4 v[212:215], v21, s[44:47], s12 offen sc1
    s_mov_b32 s12, 483328
    buffer_load_dwordx4 v[216:219], v21, s[44:47], s12 offen sc1
    s_mov_b32 s12, 487424
    buffer_load_dwordx4 v[220:223], v21, s[44:47], s12 offen sc1
    s_branch L_X1B
L_X1D:
    v_lshlrev_b32 v232, 16, v192
    v_and_b32 v233, 0xffff0000, v192
    v_lshlrev_b32 v234, 16, v194
    v_and_b32 v235, 0xffff0000, v194
    v_lshlrev_b32 v224, 16, v196
    v_and_b32 v225, 0xffff0000, v196
    v_lshlrev_b32 v226, 16, v198
    v_and_b32 v227, 0xffff0000, v198
    v_pk_add_f32 v[232:233], v[232:233], v[224:225]
    v_pk_add_f32 v[234:235], v[234:235], v[226:227]
    v_lshlrev_b32 v224, 16, v200
    v_and_b32 v225, 0xffff0000, v200
    v_lshlrev_b32 v226, 16, v202
    v_and_b32 v227, 0xffff0000, v202
    v_pk_add_f32 v[232:233], v[232:233], v[224:225]
    v_pk_add_f32 v[234:235], v[234:235], v[226:227]
    v_lshlrev_b32 v224, 16, v204
    v_and_b32 v225, 0xffff0000, v204
    v_lshlrev_b32 v226, 16, v206
    v_and_b32 v227, 0xffff0000, v206
    v_pk_add_f32 v[232:233], v[232:233], v[224:225]
    v_pk_add_f32 v[234:235], v[234:235], v[226:227]
    v_lshlrev_b32 v224, 16, v208
    v_and_b32 v225, 0xffff0000, v208
    v_lshlrev_b32 v226, 16, v210
    v_and_b32 v227, 0xffff0000, v210
    v_pk_add_f32 v[232:233], v[232:233], v[224:225]
    v_pk_add_f32 v[234:235], v[234:235], v[226:227]
    v_lshlrev_b32 v224, 16, v212
    v_and_b32 v225, 0xffff0000, v212
    v_lshlrev_b32 v226, 16, v214
    v_and_b32 v227, 0xffff0000, v214
    v_pk_add_f32 v[232:233], v[232:233], v[224:225]
    v_pk_add_f32 v[234:235], v[234:235], v[226:227]
    v_lshlrev_b32 v224, 16, v216
    v_and_b32 v225, 0xffff0000, v216
    v_lshlrev_b32 v226, 16, v218
    v_and_b32 v227, 0xffff0000, v218
    v_pk_add_f32 v[232:233], v[232:233], v[224:225]
    v_pk_add_f32 v[234:235], v[234:235], v[226:227]
    v_lshlrev_b32 v224, 16, v220
    v_and_b32 v225, 0xffff0000, v220
    v_lshlrev_b32 v226, 16, v222
    v_and_b32 v227, 0xffff0000, v222
    v_pk_add_f32 v[232:233], v[232:233], v[224:225]
    v_pk_add_f32 v[234:235], v[234:235], v[226:227]
    v_pk_fma_f32 v[232:233], v[240:241], v[232:233], v[236:237]
    v_pk_fma_f32 v[234:235], v[242:243], v[234:235], v[238:239]
    v_pk_add_f32 v[22:23], v[232:233], v[234:235]
    v_pk_mul_f32 v[28:29], v[232:233], v[232:233]
    v_pk_fma_f32 v[28:29], v[234:235], v[234:235], v[28:29]
    ds_write_b128 v25, v[232:235]
    v_add_f32 v22, v22, v23
    v_add_f32 v23, v28, v29
    s_branch L_MS1
L_46:
    v_mov_b32 v22, 0
    v_mov_b32 v23, 0
L_MS1:
    s_mov_b64 exec, s[14:15]
    v_cmp_gt_u32 vcc, 160, v0
    s_nop 1
    v_cndmask_b32 v22, 0, v22, vcc
    v_cndmask_b32 v23, 0, v23, vcc
    s_nop 0
    v_add_f32_dpp v22, v22, v22 row_shr:1 row_mask:0xf bank_mask:0xf bound_ctrl:0
    v_add_f32_dpp v23, v23, v23 row_shr:1 row_mask:0xf bank_mask:0xf bound_ctrl:0
    s_nop 0
    v_add_f32_dpp v22, v22, v22 row_shr:2 row_mask:0xf bank_mask:0xf bound_ctrl:0
    v_add_f32_dpp v23, v23, v23 row_shr:2 row_mask:0xf bank_mask:0xf bound_ctrl:0
    s_nop 0
    v_add_f32_dpp v22, v22, v22 row_shr:4 row_mask:0xf bank_mask:0xf bound_ctrl:0
    v_add_f32_dpp v23, v23, v23 row_shr:4 row_mask:0xf bank_mask:0xf bound_ctrl:0
    s_nop 0
    v_add_f32_dpp v22, v22, v22 row_shr:8 row_mask:0xf bank_mask:0xf bound_ctrl:0
    v_add_f32_dpp v23, v23, v23 row_shr:8 row_mask:0xf bank_mask:0xf bound_ctrl:0
    s_nop 0
    v_add_f32_dpp v22, v22, v22 row_bcast:15 row_mask:0xa bank_mask:0xf
    v_add_f32_dpp v23, v23, v23 row_bcast:15 row_mask:0xa bank_mask:0xf
    s_nop 0
    v_add_f32_dpp v22, v22, v22 row_bcast:31 row_mask:0xc bank_mask:0xf
    v_add_f32_dpp v23, v23, v23 row_bcast:31 row_mask:0xc bank_mask:0xf
    s_lshl_b32 s10, s4, 3
    s_add_u32 s10, s10, 134144
    v_mov_b32 v20, s10
    s_mov_b64 s[14:15], exec
    s_mov_b32 exec_lo, 0
    s_mov_b32 exec_hi, 0x80000000
    ds_write_b64 v20, v[22:23]
    s_mov_b64 exec, s[14:15]
    s_waitcnt lgkmcnt(0)
    s_barrier
    v_mov_b32 v20, 134144
    ds_read_b128 v[24:27], v20
    ds_read_b128 v[28:31], v20 offset:16
    v_lshlrev_b32 v21, 4, v0
    v_add_u32 v21, 131072, v21
    s_waitcnt lgkmcnt(0)
    v_pk_add_f32 v[24:25], v[24:25], v[26:27]
    v_pk_add_f32 v[28:29], v[28:29], v[30:31]
    v_pk_add_f32 v[22:23], v[24:25], v[28:29]
    v_mul_f32 v22, 0x3acccccd, v22
    v_mul_f32 v23, 0x3acccccd, v23
    v_fma_f32 v23, -v22, v22, v23
    v_max_f32 v23, 0, v23
    v_add_f32 v23, 0x3727c5ac, v23
    v_rsq_f32 v24, v23
    v_mov_b32 v23, v22
    v_cmp_gt_u32 vcc, 160, v0
    s_and_saveexec_b64 s[14:15], vcc
    s_cbranch_execz L_47
    v_mov_b32 v25, v24
    v_pk_add_f32 v[224:225], v[232:233], v[22:23] neg_lo:[0,1] neg_hi:[0,1]
    v_pk_mul_f32 v[228:229], v[248:249], v[24:25]
    v_pk_fma_f32 v[224:225], v[224:225], v[228:229], v[244:245]
    v_pk_add_f32 v[226:227], v[234:235], v[22:23] neg_lo:[0,1] neg_hi:[0,1]
    v_pk_mul_f32 v[230:231], v[250:251], v[24:25]
    v_pk_fma_f32 v[226:227], v[226:227], v[230:231], v[246:247]
    v_cvt_pk_bf16_f32 v26, v224, v225
    v_cvt_pk_bf16_f32 v27, v226, v227
    v_perm_b32 v28, v26, v26, s56
    v_perm_b32 v29, v26, v26, s57
    v_perm_b32 v30, v27, v27, s56
    v_perm_b32 v31, v27, v27, s57
    ds_write_b128 v21, v[28:31]
L_47:
    s_mov_b64 exec, s[14:15]
    v_lshrrev_b32 v20, 3, v2
    v_lshl_add_u32 v22, v20, 2, v3
    v_mul_u32_u24 v22, 80, v22
    s_mul_i32 s8, s4, 640
    s_add_u32 s8, s8, 131072
    v_add_u32 v21, s8, v22
    v_lshrrev_b32 v22, 1, v3
    v_cmp_eq_u32 s[12:13], v20, v22
    s_lshl_b32 s8, s4, 1
    v_add_u32 v20, s8, v20
    v_lshlrev_b32 v20, 8, v20
    v_and_b32 v22, 7, v2
    v_lshlrev_b32 v22, 5, v22
    v_and_b32 v23, 1, v3
    v_lshlrev_b32 v23, 4, v23
    v_add3_u32 v20, v20, v22, v23
    v_add_u32 v20, 135168, v20
    s_waitcnt lgkmcnt(0)
    s_barrier
    ds_read_b128 v[192:195], v21 offset:0
    ds_read_b128 v[196:199], v21 offset:16
    ds_read_b128 v[200:203], v21 offset:32
    ds_read_b128 v[204:207], v21 offset:48
    ds_read_b128 v[208:211], v21 offset:64
    s_waitcnt vmcnt(0) lgkmcnt(3)
    v_and_b32 v8, v192, v4
    v_and_b32 v9, v192, v5
    v_and_b32 v10, v192, v6
    v_and_b32 v11, v192, v7
    v_and_b32 v12, v193, v4
    v_and_b32 v13, v193, v5
    v_and_b32 v14, v193, v6
    v_and_b32 v15, v193, v7
    v_mfma_f32_16x16x32_bf16 v[16:19], v[8:11], a[0:3], 0
    v_and_b32 v8, v194, v4
    v_and_b32 v9, v194, v5
    v_and_b32 v10, v194, v6
    v_and_b32 v11, v194, v7
    v_mfma_f32_16x16x32_bf16 v[16:19], v[12:15], a[4:7], v[16:19]
    v_and_b32 v12, v195, v4
    v_and_b32 v13, v195, v5
    v_and_b32 v14, v195, v6
    v_and_b32 v15, v195, v7
    s_waitcnt lgkmcnt(2)
    v_mfma_f32_16x16x32_bf16 v[16:19], v[8:11], a[8:11], v[16:19]
    v_and_b32 v8, v196, v4
    v_and_b32 v9, v196, v5
    v_and_b32 v10, v196, v6
    v_and_b32 v11, v196, v7
    v_mfma_f32_16x16x32_bf16 v[16:19], v[12:15], a[12:15], v[16:19]
    v_and_b32 v12, v197, v4
    v_and_b32 v13, v197, v5
    v_and_b32 v14, v197, v6
    v_and_b32 v15, v197, v7
    v_mfma_f32_16x16x32_bf16 v[16:19], v[8:11], a[16:19], v[16:19]
    v_and_b32 v8, v198, v4
    v_and_b32 v9, v198, v5
    v_and_b32 v10, v198, v6
    v_and_b32 v11, v198, v7
    v_mfma_f32_16x16x32_bf16 v[16:19], v[12:15], a[20:23], v[16:19]
    v_and_b32 v12, v199, v4
    v_and_b32 v13, v199, v5
    v_and_b32 v14, v199, v6
    v_and_b32 v15, v199, v7
    s_waitcnt lgkmcnt(1)
    v_mfma_f32_16x16x32_bf16 v[16:19], v[8:11], a[24:27], v[16:19]
    v_and_b32 v8, v200, v4
    v_and_b32 v9, v200, v5
    v_and_b32 v10, v200, v6
    v_and_b32 v11, v200, v7
    v_mfma_f32_16x16x32_bf16 v[16:19], v[12:15], a[28:31], v[16:19]
    v_and_b32 v12, v201, v4
    v_and_b32 v13, v201, v5
    v_and_b32 v14, v201, v6
    v_and_b32 v15, v201, v7
    v_mfma_f32_16x16x32_bf16 v[16:19], v[8:11], a[32:35], v[16:19]
    v_and_b32 v8, v202, v4
    v_and_b32 v9, v202, v5
    v_and_b32 v10, v202, v6
    v_and_b32 v11, v202, v7
    v_mfma_f32_16x16x32_bf16 v[16:19], v[12:15], a[36:39], v[16:19]
    v_and_b32 v12, v203, v4
    v_and_b32 v13, v203, v5
    v_and_b32 v14, v203, v6
    v_and_b32 v15, v203, v7
    s_waitcnt lgkmcnt(0)
    v_mfma_f32_16x16x32_bf16 v[16:19], v[8:11], a[40:43], v[16:19]
    v_and_b32 v8, v204, v4
    v_and_b32 v9, v204, v5
    v_and_b32 v10, v204, v6
    v_and_b32 v11, v204, v7
    v_mfma_f32_16x16x32_bf16 v[16:19], v[12:15], a[44:47], v[16:19]
    v_and_b32 v12, v205, v4
    v_and_b32 v13, v205, v5
    v_and_b32 v14, v205, v6
    v_and_b32 v15, v205, v7
    v_mfma_f32_16x16x32_bf16 v[16:19], v[8:11], a[48:51], v[16:19]
    v_and_b32 v8, v206, v4
    v_and_b32 v9, v206, v5
    v_and_b32 v10, v206, v6
    v_and_b32 v11, v206, v7
    v_mfma_f32_16x16x32_bf16 v[16:19], v[12:15], a[52:55], v[16:19]
    v_and_b32 v12, v207, v4
    v_and_b32 v13, v207, v5
    v_and_b32 v14, v207, v6
    v_and_b32 v15, v207, v7
    s_waitcnt lgkmcnt(0)
    v_mfma_f32_16x16x32_bf16 v[16:19], v[8:11], a[56:59], v[16:19]
    v_and_b32 v8, v208, v4
    v_and_b32 v9, v208, v5
    v_and_b32 v10, v208, v6
    v_and_b32 v11, v208, v7
    v_mfma_f32_16x16x32_bf16 v[16:19], v[12:15], a[60:63], v[16:19]
    v_and_b32 v12, v209, v4
    v_and_b32 v13, v209, v5
    v_and_b32 v14, v209, v6
    v_and_b32 v15, v209, v7
    v_mfma_f32_16x16x32_bf16 v[16:19], v[8:11], a[64:67], v[16:19]
    v_and_b32 v8, v210, v4
    v_and_b32 v9, v210, v5
    v_and_b32 v10, v210, v6
    v_and_b32 v11, v210, v7
    v_mfma_f32_16x16x32_bf16 v[16:19], v[12:15], a[68:71], v[16:19]
    v_and_b32 v12, v211, v4
    v_and_b32 v13, v211, v5
    v_and_b32 v14, v211, v6
    v_and_b32 v15, v211, v7
    v_mfma_f32_16x16x32_bf16 v[16:19], v[8:11], a[72:75], v[16:19]
    s_nop 1
    v_mfma_f32_16x16x32_bf16 v[16:19], v[12:15], a[76:79], v[16:19]
    s_nop 7
    s_mov_b64 s[14:15], exec
    s_mov_b64 exec, s[12:13]
    ds_write_b128 v20, v[16:19]
    s_mov_b64 exec, s[14:15]
    v_lshlrev_b32 v20, 2, v0
    v_add_u32 v21, 135168, v20
    v_add_u32 v20, 134656, v20
    s_waitcnt lgkmcnt(0)
    s_barrier
    v_cmp_gt_u32 vcc, 64, v0
    s_and_saveexec_b64 s[14:15], vcc
    s_cbranch_execz L_48
    ds_read_b32 v192, v21 offset:0
    ds_read_b32 v193, v21 offset:256
    ds_read_b32 v194, v21 offset:512
    ds_read_b32 v195, v21 offset:768
    ds_read_b32 v196, v21 offset:1024
    ds_read_b32 v197, v21 offset:1280
    ds_read_b32 v198, v21 offset:1536
    ds_read_b32 v199, v21 offset:1792
    s_waitcnt lgkmcnt(0)
    v_pk_add_f32 v[192:193], v[192:193], v[196:197]
    v_pk_add_f32 v[194:195], v[194:195], v[198:199]
    v_pk_add_f32 v[192:193], v[192:193], v[194:195]
    v_add_f32 v22, v192, v193
    v_max_f32 v22, 0, v22
    v_cvt_pk_bf16_f32 v22, v22, v22
    ds_write_b32 v20, v22
L_48:
    s_mov_b64 exec, s[14:15]
    s_waitcnt lgkmcnt(0)
    s_barrier
    v_lshlrev_b32 v20, 4, v3
    s_lshl_b32 s8, s4, 6
    s_add_u32 s8, s8, 134656
    v_add_u32 v20, s8, v20
    ds_read_b128 v[192:195], v20
    s_waitcnt lgkmcnt(0)
    v_and_b32 v208, v192, v4
    v_and_b32 v209, v192, v5
    v_and_b32 v210, v192, v6
    v_and_b32 v211, v192, v7
    v_and_b32 v212, v193, v4
    v_and_b32 v213, v193, v5
    v_and_b32 v214, v193, v6
    v_and_b32 v215, v193, v7
    v_and_b32 v216, v194, v4
    v_and_b32 v217, v194, v5
    v_and_b32 v218, v194, v6
    v_and_b32 v219, v194, v7
    v_and_b32 v220, v195, v4
    v_and_b32 v221, v195, v5
    v_and_b32 v222, v195, v6
    v_and_b32 v223, v195, v7
    s_nop 1
    v_mfma_f32_16x16x32_bf16 v[224:227], v[208:211], a[80:83], 0
    v_mfma_f32_16x16x32_bf16 v[228:231], v[208:211], a[84:87], 0
    v_mfma_f32_16x16x32_bf16 v[232:235], v[208:211], a[88:91], 0
    v_mfma_f32_16x16x32_bf16 v[236:239], v[208:211], a[92:95], 0
    v_mfma_f32_16x16x32_bf16 v[240:243], v[208:211], a[160:163], 0
    v_mfma_f32_16x16x32_bf16 v[224:227], v[212:215], a[164:167], v[224:227]
    v_mfma_f32_16x16x32_bf16 v[228:231], v[212:215], a[168:171], v[228:231]
    v_mfma_f32_16x16x32_bf16 v[232:235], v[212:215], a[172:175], v[232:235]
    v_mfma_f32_16x16x32_bf16 v[236:239], v[212:215], a[176:179], v[236:239]
    v_mfma_f32_16x16x32_bf16 v[240:243], v[212:215], a[180:183], v[240:243]
    v_mfma_f32_16x16x32_bf16 v[224:227], v[216:219], a[184:187], v[224:227]
    v_mfma_f32_16x16x32_bf16 v[228:231], v[216:219], a[188:191], v[228:231]
    v_mfma_f32_16x16x32_bf16 v[232:235], v[216:219], a[192:195], v[232:235]
    v_mfma_f32_16x16x32_bf16 v[236:239], v[216:219], a[196:199], v[236:239]
    v_mfma_f32_16x16x32_bf16 v[240:243], v[216:219], a[200:203], v[240:243]
    v_mfma_f32_16x16x32_bf16 v[224:227], v[220:223], a[204:207], v[224:227]
    v_mfma_f32_16x16x32_bf16 v[228:231], v[220:223], a[208:211], v[228:231]
    v_mfma_f32_16x16x32_bf16 v[232:235], v[220:223], a[212:215], v[232:235]
    v_mfma_f32_16x16x32_bf16 v[236:239], v[220:223], a[216:219], v[236:239]
    v_mfma_f32_16x16x32_bf16 v[240:243], v[220:223], a[220:223], v[240:243]
    s_nop 7
    v_and_b32 v22, 1, v3
    v_lshlrev_b32 v22, 4, v22
    v_lshl_add_u32 v22, v2, 5, v22
    s_mul_i32 s8, s4, 2560
    s_add_u32 s8, s8, 135168
    v_add_u32 v20, s8, v22
    v_cmp_gt_u32 vcc, 2, v3
    s_and_saveexec_b64 s[14:15], vcc
    ds_write_b128 v20, v[224:227] offset:0
    ds_write_b128 v20, v[228:231] offset:512
    ds_write_b128 v20, v[232:235] offset:1024
    ds_write_b128 v20, v[236:239] offset:1536
    ds_write_b128 v20, v[240:243] offset:2048
    s_mov_b64 exec, s[14:15]
    s_waitcnt lgkmcnt(0)
    s_barrier
    v_cmp_gt_u32 vcc, 160, v0
    s_and_saveexec_b64 s[14:15], vcc
    s_cbranch_execz L_49
    v_lshlrev_b32 v21, 4, v0
    v_add_u32 v20, 135168, v21
    ds_read_b128 v[192:195], v20 offset:0
    ds_read_b128 v[196:199], v20 offset:2560
    ds_read_b128 v[200:203], v20 offset:5120
    ds_read_b128 v[204:207], v20 offset:7680
    s_waitcnt lgkmcnt(0)
    v_add_f32 v192, v192, v196
    v_add_f32 v193, v193, v197
    v_add_f32 v194, v194, v198
    v_add_f32 v195, v195, v199
    v_add_f32 v192, v192, v200
    v_add_f32 v193, v193, v201
    v_add_f32 v194, v194, v202
    v_add_f32 v195, v195, v203
    v_add_f32 v192, v192, v204
    v_add_f32 v193, v193, v205
    v_add_f32 v194, v194, v206
    v_add_f32 v195, v195, v207
    v_mov_b32 v208, v192
    v_mov_b32 v209, s42
    v_mov_b32 v210, v193
    v_mov_b32 v211, s42
    v_mov_b32 v212, v194
    v_mov_b32 v213, s42
    v_mov_b32 v214, v195
    v_mov_b32 v215, s42
    v_lshlrev_b32 v20, 5, v0
    s_lshl_b32 s8, s5, 13
    s_add_u32 s8, s8, 524288
    buffer_store_dwordx4 v[208:211], v20, s[44:47], s8 offen sc1
    buffer_store_dwordx4 v[212:215], v20, s[44:47], s8 offen offset:16 sc1
L_49:
    s_mov_b64 exec, s[14:15]
    s_cmp_ge_u32 s5, 20
    s_cbranch_scc1 L_FIN
    v_and_b32 v20, 31, v0
    v_lshrrev_b32 v21, 5, v0
    v_lshlrev_b32 v22, 13, v21
    v_lshl_add_u32 v22, v20, 3, v22
    s_lshl_b32 s8, s5, 8
    s_add_u32 s8, s8, 524288
    v_cmp_gt_u32 vcc, 3, v21
    v_add_u32 v23, 196608, v22
    s_nop 0
    v_cndmask_b32 v23, v22, v23, vcc
    s_add_u32 s9, s8, 65536
    s_add_u32 s10, s8, 131072
    s_mov_b64 s[12:13], vcc
    buffer_load_dwordx2 v[216:217], v22, s[44:47], s8 offen sc1
    buffer_load_dwordx2 v[218:219], v22, s[44:47], s9 offen sc1
    buffer_load_dwordx2 v[220:221], v22, s[44:47], s10 offen sc1
    buffer_load_dwordx2 v[222:223], v23, s[44:47], s8 offen sc1
    buffer_load_dwordx2 v[224:225], v22, s[44:47], s8 offen sc1
    buffer_load_dwordx2 v[226:227], v22, s[44:47], s9 offen sc1
    buffer_load_dwordx2 v[228:229], v22, s[44:47], s10 offen sc1
    buffer_load_dwordx2 v[230:231], v23, s[44:47], s8 offen sc1
    buffer_load_dwordx2 v[232:233], v22, s[44:47], s8 offen sc1
    buffer_load_dwordx2 v[234:235], v22, s[44:47], s9 offen sc1
    buffer_load_dwordx2 v[236:237], v22, s[44:47], s10 offen sc1
    buffer_load_dwordx2 v[238:239], v23, s[44:47], s8 offen sc1
P_50:
    s_waitcnt vmcnt(8)
    v_sad_u32 v30, v217, s42, 0
    v_sad_u32 v30, v219, s42, v30
    v_sad_u32 v30, v221, s42, v30
    v_sad_u32 v30, v223, s42, v30
    v_cmp_ne_u32 vcc, 0, v30
    s_cbranch_vccz PK_52
    s_sub_u32 s59, s59, 1
    s_cbranch_scc1 L_END
    buffer_load_dwordx2 v[216:217], v22, s[44:47], s8 offen sc1
    buffer_load_dwordx2 v[218:219], v22, s[44:47], s9 offen sc1
    buffer_load_dwordx2 v[220:221], v22, s[44:47], s10 offen sc1
    buffer_load_dwordx2 v[222:223], v23, s[44:47], s8 offen sc1
    s_waitcnt vmcnt(8)
    v_sad_u32 v30, v225, s42, 0
    v_sad_u32 v30, v227, s42, v30
    v_sad_u32 v30, v229, s42, v30
    v_sad_u32 v30, v231, s42, v30
    v_cmp_ne_u32 vcc, 0, v30
    s_cbranch_vccz PK_53
    buffer_load_dwordx2 v[224:225], v22, s[44:47], s8 offen sc1
    buffer_load_dwordx2 v[226:227], v22, s[44:47], s9 offen sc1
    buffer_load_dwordx2 v[228:229], v22, s[44:47], s10 offen sc1
    buffer_load_dwordx2 v[230:231], v23, s[44:47], s8 offen sc1
    s_waitcnt vmcnt(8)
    v_sad_u32 v30, v233, s42, 0
    v_sad_u32 v30, v235, s42, v30
    v_sad_u32 v30, v237, s42, v30
    v_sad_u32 v30, v239, s42, v30
    v_cmp_ne_u32 vcc, 0, v30
    s_cbranch_vccz PK_54
    buffer_load_dwordx2 v[232:233], v22, s[44:47], s8 offen sc1
    buffer_load_dwordx2 v[234:235], v22, s[44:47], s9 offen sc1
    buffer_load_dwordx2 v[236:237], v22, s[44:47], s10 offen sc1
    buffer_load_dwordx2 v[238:239], v23, s[44:47], s8 offen sc1
    s_branch P_50
PK_54:
    v_mov_b32 v192, v232
    v_mov_b32 v194, v234
    v_mov_b32 v196, v236
    v_mov_b32 v198, v238
    s_branch PD_51
PK_53:
    v_mov_b32 v192, v224
    v_mov_b32 v194, v226
    v_mov_b32 v196, v228
    v_mov_b32 v198, v230
    s_branch PD_51
PK_52:
    v_mov_b32 v192, v216
    v_mov_b32 v194, v218
    v_mov_b32 v196, v220
    v_mov_b32 v198, v222
PD_51:
    v_cndmask_b32 v198, 0, v198, s[12:13]
    v_add_f32 v192, v192, v194
    v_add_f32 v196, v196, v198
    v_add_f32 v192, v192, v196
    v_lshlrev_b32 v22, 2, v0
    v_add_u32 v22, 155648, v22
    ds_write_b32 v22, v192
    s_waitcnt lgkmcnt(0)
    s_barrier
    v_cmp_gt_u32 vcc, 16, v0
    s_and_saveexec_b64 s[14:15], vcc
    s_cbranch_execz L_55
    v_lshlrev_b32 v20, 3, v0
    v_add_u32 v22, 155648, v20
    ds_read_b64 v[192:193], v22 offset:0
    ds_read_b64 v[194:195], v22 offset:128
    ds_read_b64 v[196:197], v22 offset:256
    ds_read_b64 v[198:199], v22 offset:384
    ds_read_b64 v[200:201], v22 offset:512
    ds_read_b64 v[202:203], v22 offset:640
    ds_read_b64 v[204:205], v22 offset:768
    ds_read_b64 v[206:207], v22 offset:896
    s_lshl_b32 s8, s5, 7
    s_add_u32 s8, s8, 147456
    v_add_u32 v23, s8, v20
    ds_read_b64 v[208:209], v23
    ds_read_b64 v[210:211], v23 offset:4096
    s_waitcnt lgkmcnt(0)
    v_add_f32 v192, v192, v194
    v_add_f32 v193, v193, v195
    v_add_f32 v192, v192, v196
    v_add_f32 v193, v193, v197
    v_add_f32 v192, v192, v198
    v_add_f32 v193, v193, v199
    v_add_f32 v192, v192, v200
    v_add_f32 v193, v193, v201
    v_add_f32 v192, v192, v202
    v_add_f32 v193, v193, v203
    v_add_f32 v192, v192, v204
    v_add_f32 v193, v193, v205
    v_add_f32 v192, v192, v206
    v_add_f32 v193, v193, v207
    v_fma_f32 v192, v210, v192, v208
    v_fma_f32 v193, v211, v193, v209
    v_cvt_pk_bf16_f32 v192, v192, v193
    s_mov_b32 s48, s38
    s_mov_b32 s49, s39
    s_mov_b32 s50, 1280
    s_mov_b32 s51, 0x20000
    v_lshlrev_b32 v20, 2, v0
    s_lshl_b32 s8, s5, 6
    buffer_store_dword v192, v20, s[48:51], s8 offen
L_55:
    s_mov_b64 exec, s[14:15]
    s_cmp_lg_u32 s3, 40
    s_cbranch_scc1 L_FIN
    v_cmp_gt_u32 vcc, 1, v0
    s_and_saveexec_b64 s[14:15], vcc
    s_cbranch_execz L_56
    v_mov_b32 v20, 0
    v_mov_b32 v22, s97
    buffer_store_dword v22, v20, s[44:47], 0 offen sc1
L_56:
    s_mov_b64 exec, s[14:15]
L_FIN:
L_END:
    s_endpgm
.section .rodata,"a"
.p2align 6
.amdhsa_kernel adaLN_cond__compressed_kv_cla__dense_activation_relu__decode_kernel
  .amdhsa_next_free_vgpr 512
  .amdhsa_next_free_sgpr 102
  .amdhsa_accum_offset 256
  .amdhsa_group_segment_fixed_size 0
  .amdhsa_kernarg_size 112
  .amdhsa_user_sgpr_count 2
  .amdhsa_user_sgpr_kernarg_segment_ptr 1
  .amdhsa_system_sgpr_workgroup_id_x 1
.end_amdhsa_kernel
```
